```python
import torch

def _softmax(x, axis=-1):
    return torch.softmax(x, dim=axis)

def _gelu(x):
    return torch.nn.functional.gelu(x, approximate='tanh')

def _silu(x):
    return torch.nn.functional.silu(x)

def _sigmoid(x):
    return torch.sigmoid(x)

def _layernorm(x, axis=-1, eps=1e-05):
    m = x.mean(dim=axis, keepdim=True)
    v = x.var(dim=axis, keepdim=True, unbiased=False)
    return (x - m) / torch.sqrt(v + eps)

def _scatter_add(tgt, idx, src, axis=0):
    return tgt.clone().index_add_(axis, idx, src)

def _segment_sum(src, seg, n):
    out = torch.zeros((n,) + src.shape[1:], dtype=src.dtype)
    return out.index_add_(0, seg, src)

def _pad(x, pw):
    flat = tuple((v for pair in reversed(pw) for v in pair))
    return torch.nn.functional.pad(x, flat)
kernel_name = 'adaLN_cond__sliding_local_dilated__glu_gated_bilinear__prompt'

def setup_inputs():

    _w = lambda a: (lambda t: t.to(torch.bfloat16) if t.is_floating_point() else t)(torch.as_tensor(a))

    def _A_setup():
        B, S, D = (1, 2048, 640)
        return {'x': _w((lambda *s: torch.randn(*s, dtype=torch.bfloat16) * 0.05)(B, S, D)), 'wqkv': _w((lambda *s: torch.randn(*s, dtype=torch.bfloat16) * 0.05)(D, 3 * D)), 'wo': _w((lambda *s: torch.randn(*s, dtype=torch.bfloat16) * 0.05)(D, D))}
    _A_in = _A_setup()

    def _B_setup():
        B, S, D, F = (1, 2048, 640, 1728)
        return {'x': _w((lambda *s: torch.randn(*s, dtype=torch.bfloat16) * 0.05)(B, S, D)), 'w_gate': _w((lambda *s: torch.randn(*s, dtype=torch.bfloat16) * 0.8)(D, F) * D ** (-0.5)), 'w_up': _w((lambda *s: torch.randn(*s, dtype=torch.bfloat16) * 0.8)(D, F) * D ** (-0.5)), 'w_down': _w((lambda *s: torch.randn(*s, dtype=torch.bfloat16) * 0.8)(F, D) * F ** (-0.5))}
    _B_in = _B_setup()
    return {'A_x': _A_in['x'], 'A_wqkv': _A_in['wqkv'], 'A_wo': _A_in['wo'], 'B_x': _B_in['x'], 'B_w_gate': _B_in['w_gate'], 'B_w_up': _B_in['w_up'], 'B_w_down': _B_in['w_down'], 'c': _w((lambda *s: torch.randn(*s, dtype=torch.bfloat16) * 0.1)(1, 640) * 8.0), 'w_mod': _w((lambda *s: torch.randn(*s, dtype=torch.bfloat16) * 0.1)(640, 6 * 640) * 640 ** (-0.5) * 8.0)}

def reference(A_x, A_wqkv, A_wo, B_x, B_w_gate, B_w_up, B_w_down, c, w_mod):

    def _A_ref(x, wqkv, wo):
        B, S, D = x.shape
        H = 32
        Dh = D // H
        W, dil = (8, 2)
        qkv = (lambda x, *d: x.permute(*d))((x @ wqkv).reshape(B, S, 3, H, Dh), 2, 0, 3, 1, 4)
        q, k, v = (qkv[0], qkv[1], qkv[2])
        scale = Dh ** (-0.5)
        pos = torch.arange(S)
        off = torch.arange(W) * dil
        idx = pos[:, None] - off[None, :]
        mask = idx >= 0
        idx_c = torch.where(mask, idx, 0).reshape(-1)
        kg = k[:, :, idx_c, :].reshape(B, H, S, W, Dh)
        vg = v[:, :, idx_c, :].reshape(B, H, S, W, Dh)
        logits = torch.einsum('bhsd,bhswd->bhsw', q, kg) * scale
        logits = torch.where(mask[None, None, :, :], logits, -1000000000.0)
        attn = _softmax(logits, axis=-1)
        o = torch.einsum('bhsw,bhswd->bhsd', attn, vg)
        return (lambda x, *d: x.permute(*d))(o, 0, 2, 1, 3).reshape(B, S, D) @ wo

    def _B_ref(x, w_gate, w_up, w_down):
        g = torch.einsum('bsd,df->bsf', x, w_gate)
        u = torch.einsum('bsd,df->bsf', x, w_up)
        h = g * u
        return torch.einsum('bsf,fd->bsd', h, w_down)
    x = A_x
    mod = (_silu(c) @ w_mod).reshape(c.shape[0], 6, 1, -1)
    sa, ca, ga, sb, cb, gb = (mod[:, 0].clone(), mod[:, 1].clone(), mod[:, 2].clone(), mod[:, 3].clone(), mod[:, 4].clone(), mod[:, 5].clone())
    h = _layernorm(x, axis=-1) * (1 + ca) + sa
    x = x + ga * _A_ref(h, A_wqkv, A_wo)
    h = _layernorm(x, axis=-1) * (1 + cb) + sb
    x = x + gb * _B_ref(h, B_w_gate, B_w_up, B_w_down)
    return x
```

```asm
; @launch grid=(256,1,1) block=(256,1,1) lds=163840
.amdgcn_target "amdgcn-amd-amdhsa--gfx950"
.text
.globl adaLN_cond__sliding_local_dilated__glu_gated_bilinear__prompt_kernel
.p2align 8
.type adaLN_cond__sliding_local_dilated__glu_gated_bilinear__prompt_kernel,@function
adaLN_cond__sliding_local_dilated__glu_gated_bilinear__prompt_kernel:
L_begin:
    s_cmp_ge_u32 s2, 256
    s_cbranch_scc1 L_end
    s_load_dwordx16 s[28:43], s[0:1], 0
    s_load_dwordx8 s[44:51], s[0:1], 64
    s_getpc_b64 s[4:5]
L_pc1:
    s_sub_u32 s4, s4, L_pc1-L_begin
    s_subb_u32 s5, s5, 0
    s_mov_b32 s6, L_last-L_begin
    s_mov_b32 s7, 0x20000
    s_lshr_b32 s3, s2, 3
    s_lshl_b32 s3, s3, 7
    s_add_u32 s3, s3, 0
    v_min_u32 v95, 15, v0
    v_lshlrev_b32 v95, 12, v95
    v_add_u32 v95, s3, v95
    buffer_load_dword v95, v95, s[4:7], 0 offen
    v_lshrrev_b32 v2, 6, v0
    v_mov_b32 v15, v0
    v_readfirstlane_b32 s52, v2
    v_and_b32 v0, 63, v0
    s_and_b32 s57, s2, 7
    s_lshr_b32 s3, s2, 3
    s_mul_i32 s4, s57, 20
    s_add_u32 s4, s4, s3
    s_sub_u32 s4, s4, 10
    s_lshr_b32 s60, s4, 3
    s_and_b32 s61, s4, 7
    v_lshrrev_b32 v5, 3, v0
    v_and_b32 v6, 6, v5
    v_xor_b32 v6, v6, v0
    v_and_b32 v6, 7, v6
    v_lshlrev_b32 v6, 4, v6
    v_mov_b32 v7, 0x80000000
    v_mul_u32_u24 v20, 7680, v5
    v_add_u32 v20, v20, v6
    v_lshrrev_b32 v8, 5, v15
    v_lshlrev_b32 v9, 1, v8
    v_sub_u32 v9, v15, v9
    v_and_b32 v9, 31, v9
    v_cmp_gt_u32 vcc, 30, v9
    v_mul_u32_u24 v10, 26, v9
    v_lshrrev_b32 v10, 8, v10
    v_mul_u32_u24 v10, 1120, v10
    v_mul_u32_u24 v8, 3840, v8
    v_lshl_add_u32 v8, v9, 4, v8
    v_add_u32 v8, v8, v10
    v_cndmask_b32 v16, v7, v8, vcc
    s_cmp_lt_u32 s2, 80
    s_cselect_b32 s4, 0, 160
    s_sub_u32 s4, s2, s4
    s_lshr_b32 s5, s4, 2
    s_and_b32 s4, s4, 3
    s_mul_i32 s6, s4, 1228800
    s_lshl_b32 s7, s5, 7
    s_add_u32 s6, s6, s7
    s_mul_i32 s7, s52, 61440
    s_add_u32 s64, s6, s7
    s_mul_i32 s4, s60, 122880
    s_mul_i32 s5, s61, 160
    s_add_u32 s4, s4, s5
    s_lshl_b32 s5, s52, 10
    s_mov_b32 s65, 245760
    s_mov_b32 s18, 4915200
    s_mov_b32 s19, 0x20000
    s_sub_u32 s6, s2, 80
    s_cmp_lt_u32 s6, 160
    s_cselect_b64 vcc, -1, 0
    s_cselect_b32 s64, s4, s64
    s_cselect_b32 s65, 30720, s65
    s_cselect_b32 s18, 2457600, s18
    v_cndmask_b32 v16, v20, v16, vcc
    v_cndmask_b32 v17, v20, v7, vcc
    s_waitcnt lgkmcnt(0)
    s_cselect_b64 s[16:17], s[30:31], s[44:45]
    s_add_u32 m0, s5, 102400
    s_nop 0
    buffer_load_dwordx4 v16, s[16:19], s64 offen lds
    s_add_u32 m0, s5, 106496
    s_add_u32 s64, s64, s65
    buffer_load_dwordx4 v16, s[16:19], s64 offen lds
    s_add_u32 m0, s5, 110592
    s_add_u32 s64, s64, s65
    buffer_load_dwordx4 v16, s[16:19], s64 offen lds
    s_add_u32 m0, s5, 114688
    s_add_u32 s64, s64, s65
    buffer_load_dwordx4 v16, s[16:19], s64 offen lds
    s_add_u32 m0, s5, 118784
    s_add_u32 s64, s64, s65
    buffer_load_dwordx4 v17, s[16:19], s64 offen lds
    s_and_b32 s53, s3, 7
    s_and_b32 s55, s3, 15
    s_lshr_b32 s3, s3, 3
    s_lshl_b32 s54, s57, 2
    s_add_u32 s54, s54, s3
    s_lshr_b32 s56, s54, 1
    s_and_b32 s4, s2, 3
    s_mul_i32 s4, s4, 160
    v_add_u32 v22, s4, v15
    v_min_u32 v22, 639, v22
    v_lshlrev_b32 v22, 1, v22
    global_load_ushort v23, v22, s[42:43]
    s_add_u32 s34, s50, 22675456
    s_addc_u32 s35, s51, 0
    s_load_dword s58, s[34:35], 0
    v_mul_u32_u24 v93, 1280, v5
    v_add_u32 v93, v93, v6
    s_cmp_ge_u32 s53, 5
    s_cselect_b32 s66, 5, 0
    s_sub_u32 s66, s53, s66
    s_lshl_b32 s66, s66, 1
    s_lshr_b32 s67, s52, 1
    s_add_u32 s66, s66, s67
    s_mul_i32 s66, s66, 10240
    s_and_b32 s68, s52, 1
    s_mul_i32 s67, s68, 640
    s_mul_i32 s68, s68, 5120
    s_mul_i32 s69, s54, 81920
    s_sub_u32 s69, s69, 20480
    s_mov_b32 s8, s28
    s_mov_b32 s9, s29
    s_mov_b32 s10, 2621440
    s_mov_b32 s11, 0x20000
    s_add_u32 s70, s66, s69
    s_max_i32 s70, s70, 0
    s_add_u32 s70, s70, s67
    s_add_u32 s71, s66, s68
    s_add_u32 m0, s71, 0
    s_nop 0
    buffer_load_dwordx4 v93, s[8:11], s70 offen offset:0 lds
    s_add_u32 m0, s71, 896
    s_nop 0
    buffer_load_dwordx4 v93, s[8:11], s70 offen offset:128 lds
    s_add_u32 m0, s71, 1792
    s_nop 0
    buffer_load_dwordx4 v93, s[8:11], s70 offen offset:256 lds
    s_add_u32 m0, s71, 2688
    s_nop 0
    buffer_load_dwordx4 v93, s[8:11], s70 offen offset:384 lds
    s_add_u32 m0, s71, 3584
    s_nop 0
    buffer_load_dwordx4 v93, s[8:11], s70 offen offset:512 lds
    v_lshlrev_b32 v1, 4, v0
    v_and_b32 v3, 15, v0
    v_lshrrev_b32 v4, 4, v0
    s_mov_b32 s12, s50
    s_mov_b32 s13, s51
    s_mov_b32 s14, 23199744
    s_mov_b32 s15, 0x20000
    s_mov_b32 s24, s46
    s_mov_b32 s25, s47
    s_mov_b32 s26, 2621440
    s_mov_b32 s27, 0x20000
    s_mov_b32 s20, s44
    s_mov_b32 s21, s45
    s_mov_b32 s22, 4915200
    s_mov_b32 s23, 0x20000
    s_lshl_b32 s64, s2, 2
    s_add_u32 s64, s64, s52
    s_lshl_b32 s4, s54, 5
    s_lshl_b32 s5, s53, 2
    s_add_u32 s4, s4, s5
    s_add_u32 s6, s4, s52
    v_mov_b32 v86, 0x80000000
    s_lshl_b32 s4, s6, 8
    s_add_u32 s4, s4, 22347776
    v_writelane_b32 v86, s4, 20
    s_lshl_b32 s4, s6, 8
    s_add_u32 s4, s4, 22347904
    v_writelane_b32 v86, s4, 21
    s_lshl_b32 s4, s6, 7
    s_add_u32 s4, s4, 22740992
    v_writelane_b32 v86, s4, 22
    s_lshl_b32 s4, s6, 6
    s_add_u32 s4, s4, 22872064
    v_writelane_b32 v86, s4, 23
    s_lshl_b32 s4, s64, 7
    s_add_u32 s4, s4, 22609920
    v_mov_b32 v94, v86
    v_writelane_b32 v94, s4, 24
    v_mul_u32_u24 v2, 12, v4
    v_add_lshl_u32 v2, v2, v3, 4
    v_cmp_gt_u32 vcc, 12, v3
    s_getreg_b32 s63, hwreg(HW_REG_XCC_ID)
    s_and_b32 s63, s63, 7
    v_cndmask_b32 v2, v7, v2, vcc
    s_cmp_lt_u32 s2, 80
    s_cselect_b32 s4, 0, 160
    s_sub_u32 s4, s2, s4
    s_lshr_b32 s5, s4, 2
    s_and_b32 s4, s4, 3
    s_mul_i32 s4, s4, 15360
    s_lshl_b32 s5, s5, 8
    s_add_u32 s4, s4, s5
    s_lshl_b32 s5, s52, 6
    s_add_u32 s4, s4, s5
    s_add_u32 s62, s4, 22609920
    s_lshl_b32 s4, s61, 2
    s_add_u32 s4, s4, s52
    s_mul_i32 s4, s4, 20
    s_add_u32 s4, s4, s60
    s_mul_i32 s4, s4, 3840
    s_sub_u32 s3, s2, 80
    s_cmp_lt_u32 s3, 160
    s_cselect_b32 s62, s4, s62
    v_and_b32 v8, 3, v0
    v_bfe_u32 v9, v0, 2, 2
    v_lshl_add_u32 v10, v4, 3, v9
    v_lshlrev_b32 v10, 9, v10
    v_add_u32 v10, 102400, v10
    s_mul_i32 s4, s52, 40
    v_lshl_add_u32 v9, v9, 5, s4
    v_min_u32 v11, 2, v8
    v_mul_u32_u24 v11, 160, v11
    v_add_u32 v11, v11, v9
    v_lshl_add_u32 v9, v8, 3, v9
    s_movk_i32 s4, 0x1ff
    v_add_u32 v12, 0, v9
    v_and_or_b32 v140, v12, s4, v10
    v_add_u32 v12, 128, v9
    v_and_or_b32 v141, v12, s4, v10
    v_add_u32 v12, 160, v9
    v_and_or_b32 v142, v12, s4, v10
    v_add_u32 v12, 288, v9
    v_and_or_b32 v143, v12, s4, v10
    v_add_u32 v12, 320, v9
    v_and_or_b32 v144, v12, s4, v10
    v_add_u32 v12, 448, v9
    v_and_or_b32 v145, v12, s4, v10
    v_add_u32 v12, 32, v11
    v_and_or_b32 v146, v12, s4, v10
    v_add_u32 v12, 160, v11
    v_and_or_b32 v147, v12, s4, v10
    v_lshrrev_b32 v9, 2, v0
    v_and_b32 v10, 6, v9
    v_lshlrev_b32 v10, 4, v10
    v_lshlrev_b32 v9, 7, v9
    s_lshl_b32 s4, s52, 5
    v_lshl_add_u32 v67, v8, 3, s4
    v_xor_b32 v67, v67, v10
    v_add_u32 v67, v67, v9
    v_add_u32 v67, 102400, v67
    v_lshlrev_b32 v68, 3, v4
    v_add_u32 v68, 155648, v68
    v_cmp_eq_u32 vcc, 0, v3
    s_sub_u32 s4, s2, 116
    s_cmp_ge_u32 s4, 112
    s_cselect_b32 s4, 0, 0x80000000
    v_cndmask_b32 v69, v7, v0, vcc
    v_or_b32 v70, s4, v69
    v_or_b32 v71, s4, v20
    buffer_load_dword v87, v94, s[12:15], 0 offen
    v_lshrrev_b32 v48, 5, v0
    v_and_b32 v49, 3, v5
    s_cmp_lt_u32 s64, 540
    s_cbranch_scc0 L_else_1
    s_mov_b32 s16, s36
    s_mov_b32 s17, s37
    s_mov_b32 s18, 2211840
    s_mov_b32 s19, 0x20000
    s_mov_b32 s48, s38
    s_mov_b32 s49, s39
    s_mov_b32 s50, 2211840
    s_mov_b32 s51, 0x20000
    s_mul_hi_u32 s76, s64, 159072863
    s_mul_i32 s5, s76, 27
    s_sub_u32 s77, s64, s5
    s_mul_i32 s6, s76, 110592
    s_lshl_b32 s7, s77, 7
    s_add_u32 s28, s6, s7
    s_mov_b32 s29, s28
    s_mov_b32 s30, 55296
    s_mov_b32 s31, 13824
    v_lshl_add_u32 v65, v48, 3, v49
    v_mul_u32_u24 v65, 3456, v65
    v_add_u32 v65, v65, v6
    s_branch L_join_2
L_else_1:
    s_sub_u32 s3, s64, 540
    s_cmp_lt_u32 s3, 100
    s_cselect_b64 s[16:17], s[32:33], s[40:41]
    s_mov_b32 s18, 2211840
    s_cselect_b32 s18, 819200, s18
    s_cselect_b32 s4, 0, 100
    s_mov_b64 s[48:49], s[16:17]
    s_mov_b32 s50, s18
    s_mov_b32 s51, 0x20000
    s_sub_u32 s3, s3, s4
    s_mul_hi_u32 s76, s3, 858993460
    s_mul_i32 s4, s76, 5
    s_sub_u32 s77, s3, s4
    s_mul_i32 s4, s76, 40
    s_mul_i32 s5, s76, 160
    s_sub_u32 s5, s5, 2544
    s_cmp_lt_u32 s76, 16
    s_cselect_b32 s4, s4, s5
    s_cselect_b32 s5, 20, 40
    s_cselect_b32 s6, 8, 80
    s_cselect_b32 s7, 4, 20
    s_lshl_b32 s3, s76, 5
    s_cmp_lt_u32 s64, 640
    s_cselect_b32 s4, s4, s3
    s_cselect_b32 s5, s5, 16
    s_cselect_b32 s6, s6, 4
    s_cselect_b32 s7, s7, 8
    v_mad_u32_u24 v65, v48, s7, v49
    v_mul_u32_u24 v65, 1280, v65
    s_cmp_lt_u32 s64, 910
    s_cselect_b32 s7, 0, 0x80000000
    v_add3_u32 v65, v65, v6, s7
    s_mul_i32 s4, s4, 1280
    s_lshl_b32 s7, s77, 8
    s_add_u32 s28, s4, s7
    s_add_u32 s29, s28, 128
    s_mul_i32 s30, s5, 1280
    s_mul_i32 s31, s6, 1280
L_join_2:
    s_lshl_b32 s32, s52, 13
    v_and_b32 v8, 6, v3
    v_xor_b32 v8, v8, v4
    v_lshlrev_b32 v8, 4, v8
    v_and_b32 v9, 7, v3
    v_lshl_add_u32 v8, v9, 7, v8
    v_lshrrev_b32 v9, 3, v3
    v_mul_u32_u24 v9, 10240, v9
    v_add_u32 v85, v8, v9
    s_and_b32 s4, s52, 1
    s_mul_i32 s5, s52, 5
    s_lshr_b32 s5, s5, 1
    s_lshl_b32 s5, s5, 10
    s_lshl_b32 s6, s4, 6
    v_xor_b32 v8, s6, v85
    v_xor_b32 v9, 64, v8
    v_add_u32 v8, s5, v8
    s_lshl_b32 s4, s4, 10
    s_add_u32 s5, s5, s4
    v_add_u32 v9, s5, v9
    v_add_u32 v10, 81920, v8
    v_add_u32 v11, 81920, v9
    v_mov_b32 v76, 0x3f803f80
    v_mov_b32 v77, 0x3f803f80
    v_mov_b32 v78, 0x3f803f80
    v_mov_b32 v79, 0x3f803f80
    v_and_b32 v84, 31, v0
    v_mul_u32_u24 v84, 20, v84
    v_lshrrev_b32 v75, 5, v0
    v_mul_u32_u24 v74, 2560, v75
    v_add_u32 v74, v74, v84
    s_mul_hi_u32 s5, s60, 858993460
    s_mul_i32 s6, s5, 5
    s_sub_u32 s4, s60, s6
    s_lshl_b32 s4, s4, 2
    s_lshl_b32 s5, s5, 7
    s_add_u32 s4, s4, s5
    s_lshl_b32 s5, s61, 9
    s_add_u32 s4, s4, s5
    s_lshl_b32 s5, s52, 13
    s_add_u32 s4, s4, s5
    s_add_u32 s0, s34, s4
    s_addc_u32 s1, s35, 0
    v_lshlrev_b32 v26, 1, v15
    v_add_u32 v26, 155648, v26
    s_add_u32 m0, s32, 122880
    s_nop 0
    buffer_load_dwordx4 v65, s[16:19], s28 offen nt lds
    s_add_u32 m0, s32, 123904
    s_add_u32 s47, s28, s30
    buffer_load_dwordx4 v65, s[16:19], s47 offen nt lds
    s_waitcnt vmcnt(8)
    v_lshlrev_b32 v23, 16, v23
    v_mul_f32 v25, 0xbfb8aa3b, v23
    v_exp_f32 v25, v25
    s_nop 0
    v_add_f32 v25, 1.0, v25
    v_rcp_f32 v25, v25
    s_nop 0
    v_mul_f32 v25, v23, v25
    v_cvt_pk_bf16_f32 v25, v25, v25
    ds_write_b16 v26, v25
    s_waitcnt lgkmcnt(0)
    s_add_u32 s58, s58, 0x01010101
    s_and_b32 s4, s58, 0xfffffff8
    s_or_b32 s63, s63, s4
    s_barrier
    s_sub_u32 s3, s2, 80
    s_cmp_lt_u32 s3, 160
    s_cbranch_scc0 L_else_3
    ds_read_b64_tr_b16 a[0:1], v140 offset:0
    ds_read_b64_tr_b16 a[2:3], v141 offset:2048
    ds_read_b64_tr_b16 a[4:5], v142 offset:0
    ds_read_b64_tr_b16 a[6:7], v143 offset:2048
    ds_read_b64_tr_b16 a[8:9], v144 offset:0
    ds_read_b64_tr_b16 a[10:11], v145 offset:2048
    ds_read_b64_tr_b16 a[12:13], v146 offset:0
    ds_read_b64_tr_b16 a[14:15], v147 offset:2048
    s_waitcnt lgkmcnt(6)
    buffer_store_dwordx4 a[0:3], v1, s[12:15], s62 offen offset:0 sc1
    s_waitcnt lgkmcnt(4)
    buffer_store_dwordx4 a[4:7], v1, s[12:15], s62 offen offset:1024 sc1
    s_waitcnt lgkmcnt(2)
    buffer_store_dwordx4 a[8:11], v1, s[12:15], s62 offen offset:2048 sc1
    s_waitcnt lgkmcnt(0)
    buffer_store_dwordx4 a[12:15], v2, s[12:15], s62 offen offset:3072 sc1
    s_branch L_join_4
L_else_3:
    ds_read_b64_tr_b16 a[16:17], v67 offset:0
    ds_read_b64_tr_b16 a[18:19], v67 offset:2048
    ds_read2_b64 a[36:39], v68 offset0:0 offset1:4
    ds_read_b64_tr_b16 a[20:21], v67 offset:4096
    ds_read_b64_tr_b16 a[22:23], v67 offset:6144
    ds_read2_b64 a[40:43], v68 offset0:8 offset1:12
    ds_read_b64_tr_b16 a[24:25], v67 offset:8192
    ds_read_b64_tr_b16 a[26:27], v67 offset:10240
    ds_read2_b64 a[44:47], v68 offset0:16 offset1:20
    ds_read_b64_tr_b16 a[28:29], v67 offset:12288
    ds_read_b64_tr_b16 a[30:31], v67 offset:14336
    ds_read2_b64 a[48:51], v68 offset0:24 offset1:28
    ds_read_b64_tr_b16 a[32:33], v67 offset:16384
    ds_read_b64_tr_b16 a[34:35], v67 offset:18432
    ds_read2_b64 a[52:55], v68 offset0:32 offset1:36
    v_mov_b32 v28, 0xff
    s_waitcnt lgkmcnt(12)
    v_mfma_f32_16x16x32_bf16 v[24:27], a[16:19], a[36:39], 0
    s_waitcnt lgkmcnt(9)
    v_mfma_f32_16x16x32_bf16 v[24:27], a[20:23], a[40:43], v[24:27]
    s_waitcnt lgkmcnt(6)
    v_mfma_f32_16x16x32_bf16 v[24:27], a[24:27], a[44:47], v[24:27]
    s_waitcnt lgkmcnt(3)
    v_mfma_f32_16x16x32_bf16 v[24:27], a[28:31], a[48:51], v[24:27]
    s_waitcnt lgkmcnt(0)
    v_mfma_f32_16x16x32_bf16 v[24:27], a[32:35], a[52:55], v[24:27]
    s_nop 7
    v_add_u32 v24, 0x80, v24
    v_add_u32 v25, 0x80, v25
    v_add_u32 v26, 0x80, v26
    v_add_u32 v27, 0x80, v27
    v_bfi_b32 v24, v28, s58, v24
    v_bfi_b32 v25, v28, s58, v25
    v_bfi_b32 v26, v28, s58, v26
    v_bfi_b32 v27, v28, s58, v27
    buffer_store_dwordx4 v[24:27], v69, s[12:15], s62 offen sc1
L_join_4:
    s_add_u32 s66, s66, 20480
    s_cmp_ge_u32 s66, 102400
    s_cselect_b32 s70, 102400, 0
    s_sub_u32 s66, s66, s70
    s_add_u32 s70, s66, s69
    s_max_i32 s70, s70, 0
    s_add_u32 s70, s70, s67
    s_add_u32 s71, s66, s68
    s_add_u32 m0, s71, 0
    s_nop 0
    buffer_load_dwordx4 v93, s[8:11], s70 offen offset:0 lds
    s_add_u32 m0, s32, 124928
    s_add_u32 s28, s28, s31
    buffer_load_dwordx4 v65, s[16:19], s28 offen nt lds
    s_add_u32 m0, s32, 125952
    s_add_u32 s47, s28, s30
    buffer_load_dwordx4 v65, s[16:19], s47 offen nt lds
    s_add_u32 m0, s71, 896
    s_nop 0
    buffer_load_dwordx4 v93, s[8:11], s70 offen offset:128 lds
    s_add_u32 m0, s32, 126976
    s_nop 0
    buffer_load_dwordx4 v65, s[48:51], s29 offen nt lds
    s_add_u32 m0, s32, 128000
    s_add_u32 s47, s29, s30
    buffer_load_dwordx4 v65, s[48:51], s47 offen nt lds
    s_add_u32 m0, s71, 1792
    s_nop 0
    buffer_load_dwordx4 v93, s[8:11], s70 offen offset:256 lds
    s_waitcnt vmcnt(11)
    s_barrier
    s_cmp_ge_u32 s53, 5
    s_cselect_b32 s4, 5, 0
    s_sub_u32 s4, s53, s4
    s_mul_i32 s5, s4, 20480
    v_add_u32 v128, s5, v8
    v_add_u32 v129, s5, v9
    ds_read_b128 v[100:103], v128 offset:0
    ds_read_b128 v[104:107], v129 offset:0
    ds_read_b128 v[108:111], v128 offset:1024
    ds_read_b128 v[112:115], v129 offset:1024
    ds_read_b128 v[116:119], v128 offset:2048
    s_lshl_b32 s4, s4, 8
    s_mul_i32 s5, s54, 1280
    s_add_u32 s61, s5, 23003136
    s_add_u32 s60, s61, s4
    v_lshrrev_b32 v130, 2, v3
    v_cmp_eq_u32 s[6:7], v130, v4
    v_and_b32 v130, 3, v3
    v_cmp_eq_u32 s[4:5], 1, v130
    v_cmp_eq_u32 s[64:65], 2, v130
    v_cmp_eq_u32 vcc, 3, v130
    v_lshlrev_b32 v131, 5, v3
    v_add_u32 v131, 156160, v131
    s_lshl_b32 s3, s52, 3
    v_add_u32 v130, s3, v131
    s_waitcnt lgkmcnt(4)
    v_mfma_f32_16x16x32_bf16 v[120:123], v[100:103], v[100:103], 0
    v_mfma_f32_16x16x32_bf16 v[124:127], v[76:79], v[100:103], 0
    s_waitcnt lgkmcnt(3)
    v_mfma_f32_16x16x32_bf16 v[120:123], v[104:107], v[104:107], v[120:123]
    v_mfma_f32_16x16x32_bf16 v[124:127], v[76:79], v[104:107], v[124:127]
    s_waitcnt lgkmcnt(2)
    v_mfma_f32_16x16x32_bf16 v[120:123], v[108:111], v[108:111], v[120:123]
    v_mfma_f32_16x16x32_bf16 v[124:127], v[76:79], v[108:111], v[124:127]
    s_waitcnt lgkmcnt(1)
    v_mfma_f32_16x16x32_bf16 v[120:123], v[112:115], v[112:115], v[120:123]
    v_mfma_f32_16x16x32_bf16 v[124:127], v[76:79], v[112:115], v[124:127]
    s_waitcnt lgkmcnt(0)
    v_mfma_f32_16x16x32_bf16 v[120:123], v[116:119], v[116:119], v[120:123]
    v_mfma_f32_16x16x32_bf16 v[124:127], v[76:79], v[116:119], v[124:127]
    s_cmp_ge_u32 s53, 5
    s_cselect_b32 s3, 1, s52
    s_lshl_b32 s3, s3, 30
    v_lshlrev_b32 v132, 28, v4
    v_or3_b32 v132, v132, s3, v1
    s_nop 2
    v_cndmask_b32 v125, v120, v121, s[4:5]
    v_cndmask_b32 v125, v125, v122, s[64:65]
    v_cndmask_b32 v125, v125, v123, vcc
    s_mov_b64 exec, s[6:7]
    ds_write_b64 v130, v[124:125]
    s_mov_b64 exec, -1
    s_waitcnt vmcnt(7)
    s_waitcnt lgkmcnt(0)
    s_barrier
    ds_read_b128 v[100:103], v131
    ds_read_b128 v[104:107], v131 offset:16
    s_mov_b32 s4, 0xbacccccd
    s_mov_b32 s5, 0x07060302
    s_mov_b32 s6, 0xffff0000
    v_mov_b32 v109, s58
    v_lshlrev_b32 v110, 16, v109
    s_waitcnt lgkmcnt(1)
    v_pk_add_f32 v[100:101], v[100:101], v[102:103]
    s_waitcnt lgkmcnt(0)
    v_pk_add_f32 v[104:105], v[104:105], v[106:107]
    v_pk_add_f32 v[100:101], v[100:101], v[104:105]
    v_mul_f32 v100, s4, v100
    v_mul_f32 v101, s4, v101
    v_fma_f32 v101, -v100, v100, -v101
    v_and_b32 v102, s6, v100
    v_max_f32 v101, 0, v101
    v_sub_f32 v102, v100, v102
    v_add_f32 v101, 0x3727c5ac, v101
    v_and_b32 v103, s6, v102
    v_sqrt_f32 v101, v101
    v_sub_f32 v103, v102, v103
    v_perm_b32 v104, v102, v100, s5
    v_and_b32 v102, s6, v101
    v_perm_b32 v105, v109, v103, s5
    v_sub_f32 v102, v101, v102
    v_and_b32 v103, s6, v102
    v_perm_b32 v106, v102, v101, s5
    v_sub_f32 v103, v102, v103
    v_perm_b32 v107, v110, v103, s5
    buffer_store_dwordx4 v[104:107], v132, s[12:15], s60 offen sc1
    v_and_b32 v92, 1, v4
    v_cmp_eq_u32 vcc, 0, v92
    v_lshlrev_b32 v92, 3, v92
    v_lshl_add_u32 v92, v3, 4, v92
    v_cndmask_b32 v90, v110, v109, vcc
    v_and_b32 v90, s6, v90
    s_sub_u32 s3, s2, 80
    s_cmp_lt_u32 s3, 160
    s_cbranch_scc0 L_else_5
    s_atomic_swap s58, s[0:1], 0x1000
    s_atomic_swap s58, s[0:1], 0x2000
L_else_5:
    s_add_u32 m0, s32, 129024
    s_add_u32 s29, s29, s31
    buffer_load_dwordx4 v65, s[48:51], s29 offen nt lds
    s_add_u32 m0, s32, 130048
    s_add_u32 s47, s29, s30
    buffer_load_dwordx4 v65, s[48:51], s47 offen nt lds
    s_lshl_b32 s62, s57, 12
    s_lshl_b32 s5, s53, 9
    s_add_u32 s62, s62, s5
    s_lshl_b32 s5, s52, 7
    s_add_u32 s62, s62, s5
    s_add_u32 s62, s62, 4096
    s_lshl_b32 s0, s56, 9
    s_lshr_b32 s5, s55, 2
    s_lshl_b32 s5, s5, 7
    s_add_u32 s0, s0, s5
    s_and_b32 s5, s55, 3
    s_lshl_b32 s5, s5, 2
    s_add_u32 s0, s0, s5
    s_add_u32 s0, s0, s34
    s_addc_u32 s1, s35, 0
    s_lshl_b32 s64, s2, 2
    s_add_u32 s64, s64, s52
    v_and_b32 v200, 3, v0
    v_lshrrev_b32 v201, 2, v0
    v_and_b32 v202, 6, v201
    v_lshlrev_b32 v202, 4, v202
    s_lshl_b32 s65, s52, 13
    s_add_u32 s65, s65, 122880
    v_lshl_add_u32 v201, v201, 7, s65
    v_and_b32 v203, 1, v200
    v_lshrrev_b32 v204, 1, v200
    s_cmp_lt_u32 s64, 540
    s_cbranch_scc0 L_else_7
    s_mul_i32 s5, s77, 160
    s_add_u32 s4, s76, s5
    s_lshl_b32 s4, s4, 10
    s_add_u32 s36, s4, 3342336
    s_add_u32 s37, s4, 3362816
    s_add_u32 s38, s4, 3383296
    s_add_u32 s39, s4, 3403776
    s_add_u32 s40, s4, 3424256
    s_add_u32 s41, s4, 3444736
    s_add_u32 s42, s4, 3465216
    s_add_u32 s43, s4, 3485696
    v_lshl_add_u32 v201, v203, 12, v201
    v_lshl_add_u32 v201, v204, 3, v201
    v_xor_b32 v205, 0, v202
    v_add_u32 v56, v205, v201
    v_xor_b32 v205, 16, v202
    v_add_u32 v57, v205, v201
    v_xor_b32 v205, 32, v202
    v_add_u32 v58, v205, v201
    v_xor_b32 v205, 48, v202
    v_add_u32 v59, v205, v201
    v_xor_b32 v205, 64, v202
    v_add_u32 v60, v205, v201
    v_xor_b32 v205, 80, v202
    v_add_u32 v61, v205, v201
    v_xor_b32 v205, 96, v202
    v_add_u32 v62, v205, v201
    v_xor_b32 v205, 112, v202
    v_add_u32 v63, v205, v201
    v_and_b32 v64, 9, v3
    v_and_b32 v205, 2, v3
    v_lshl_or_b32 v64, v205, 1, v64
    v_bfe_u32 v205, v3, 2, 1
    v_lshl_or_b32 v64, v205, 1, v64
    v_lshlrev_b32 v64, 4, v64
    v_lshl_add_u32 v64, v4, 8, v64
    s_branch L_join_8
L_else_7:
    s_cmp_lt_u32 s64, 910
    s_cselect_b32 s7, 0, 0x80000000
    v_or_b32 v64, s7, v1
    s_mov_b32 s65, 276480
    s_mov_b32 s3, 7798784
    s_cmp_lt_u32 s64, 640
    s_cselect_b32 s65, 102400, s65
    s_cselect_b32 s3, 2490368, s3
    s_mul_i32 s4, s76, 5120
    s_add_u32 s3, s3, s4
    s_mov_b32 s76, 49408
    s_cmp_eq_u32 s77, 1
    s_cselect_b32 s76, 600137, s76
    s_cmp_eq_u32 s77, 2
    s_cselect_b32 s76, 397667, s76
    s_cmp_eq_u32 s77, 3
    s_cselect_b32 s76, 210100, s76
    s_cmp_eq_u32 s77, 4
    s_cselect_b32 s76, 499406, s76
    v_lshlrev_b32 v200, 4, v200
    v_lshlrev_b32 v203, 4, v203
    v_lshl_add_u32 v203, v204, 3, v203
    s_bfe_u32 s4, s76, 0x30000
    s_bfe_u32 s5, s76, 0x20003
    s_mul_i32 s4, s4, s65
    s_lshl_b32 s6, s5, 11
    s_add_u32 s4, s4, s6
    s_add_u32 s36, s4, s3
    s_cmp_eq_u32 s5, 2
    s_cselect_b32 s6, s65, 1024
    s_cselect_b32 s7, 32, 8
    s_cselect_b64 vcc, -1, 0
    s_add_u32 s37, s36, s6
    v_cndmask_b32 v205, v200, v203, vcc
    v_add_u32 v206, s7, v205
    v_xad_u32 v56, v205, v202, v201
    v_xad_u32 v57, v206, v202, v201
    s_bfe_u32 s4, s76, 0x30005
    s_bfe_u32 s5, s76, 0x20008
    s_mul_i32 s4, s4, s65
    s_lshl_b32 s6, s5, 11
    s_add_u32 s4, s4, s6
    s_add_u32 s38, s4, s3
    s_cmp_eq_u32 s5, 2
    s_cselect_b32 s6, s65, 1024
    s_cselect_b32 s7, 32, 8
    s_cselect_b64 vcc, -1, 0
    s_add_u32 s39, s38, s6
    v_cndmask_b32 v205, v200, v203, vcc
    v_add_u32 v205, 64, v205
    v_add_u32 v206, s7, v205
    v_xad_u32 v58, v205, v202, v201
    v_xad_u32 v59, v206, v202, v201
    s_bfe_u32 s4, s76, 0x3000a
    s_bfe_u32 s5, s76, 0x2000d
    s_mul_i32 s4, s4, s65
    s_lshl_b32 s6, s5, 11
    s_add_u32 s4, s4, s6
    s_add_u32 s40, s4, s3
    s_cmp_eq_u32 s5, 2
    s_cselect_b32 s6, s65, 1024
    s_cselect_b32 s7, 32, 8
    s_cselect_b64 vcc, -1, 0
    s_add_u32 s41, s40, s6
    v_cndmask_b32 v205, v200, v203, vcc
    v_add_u32 v201, 4096, v201
    v_add_u32 v206, s7, v205
    v_xad_u32 v60, v205, v202, v201
    v_xad_u32 v61, v206, v202, v201
    s_bfe_u32 s4, s76, 0x3000f
    s_bfe_u32 s5, s76, 0x20012
    s_mul_i32 s4, s4, s65
    s_lshl_b32 s6, s5, 11
    s_add_u32 s4, s4, s6
    s_add_u32 s42, s4, s3
    s_cmp_eq_u32 s5, 2
    s_cselect_b32 s6, s65, 1024
    s_cselect_b32 s7, 32, 8
    s_cselect_b64 vcc, -1, 0
    s_add_u32 s43, s42, s6
    v_cndmask_b32 v205, v200, v203, vcc
    v_add_u32 v205, 64, v205
    v_add_u32 v206, s7, v205
    v_xad_u32 v62, v205, v202, v201
    v_xad_u32 v63, v206, v202, v201
L_join_8:
    s_cmp_lt_u32 s2, 116
    s_cselect_b32 s4, -96, 16
    s_sub_u32 s4, s2, s4
    s_lshr_b32 s5, s4, 2
    s_and_b32 s4, s4, 3
    s_mul_i32 s6, s4, 1228800
    s_lshl_b32 s7, s5, 7
    s_add_u32 s6, s6, s7
    s_mul_i32 s7, s52, 61440
    s_add_u32 s44, s6, s7
    s_mul_i32 s4, s4, 15360
    s_lshl_b32 s5, s5, 8
    s_add_u32 s4, s4, s5
    s_lshl_b32 s5, s52, 6
    s_add_u32 s4, s4, s5
    s_add_u32 s45, s4, 22609920
    s_lshr_b32 s4, s53, 1
    s_mul_i32 s4, s4, 5
    s_and_b32 s5, s53, 1
    s_mul_i32 s6, s5, 3
    s_add_u32 s6, s6, s4
    s_add_u32 s4, s4, 2
    s_add_u32 s7, s52, 1
    s_mul_i32 s7, s7, 20480
    s_lshr_b32 s3, s6, 1
    s_lshl_b32 s3, s3, 10
    s_add_u32 s3, s3, s7
    s_and_b32 s65, s6, 1
    s_lshl_b32 s65, s65, 6
    v_xor_b32 v12, s65, v85
    v_add_u32 v12, s3, v12
    s_add_u32 s6, s6, 1
    s_lshr_b32 s3, s6, 1
    s_lshl_b32 s3, s3, 10
    s_add_u32 s3, s3, s7
    s_and_b32 s65, s6, 1
    s_lshl_b32 s65, s65, 6
    v_xor_b32 v13, s65, v85
    v_add_u32 v13, s3, v13
    s_lshr_b32 s3, s4, 1
    s_lshl_b32 s3, s3, 10
    s_add_u32 s3, s3, s7
    s_and_b32 s65, s4, 1
    s_lshl_b32 s65, s65, 6
    s_lshl_b32 s5, s5, 5
    s_xor_b32 s65, s65, s5
    v_and_b32 v14, 32, v0
    v_xor_b32 v201, v14, v85
    v_xor_b32 v201, s65, v201
    v_lshrrev_b32 v14, 2, v14
    v_add_u32 v14, v14, v201
    v_add_u32 v14, s3, v14
    v_lshlrev_b32 v201, 1, v75
    v_sub_u32 v84, v84, v201
    v_cvt_f32_u32 v75, v75
    v_lshrrev_b32 v200, 2, v3
    v_cmp_eq_u32 s[4:5], v200, v4
    v_and_b32 v200, 1, v3
    v_cmp_eq_u32 vcc, 0, v200
    v_mov_b32 v200, 0x01000c0c
    v_mov_b32 v201, 0x0c0c0100
    v_mov_b32 v202, 0x0c0c0c0c
    v_cndmask_b32 v200, v200, v201, vcc
    v_cndmask_b32 v200, v202, v200, s[4:5]
    v_and_b32 v201, 2, v3
    v_cmp_eq_u32 vcc, 0, v201
    v_mov_b32 v82, 0x03020302
    v_mov_b32 v201, 0x01000100
    v_cndmask_b32 v80, v202, v200, vcc
    v_cndmask_b32 v81, v200, v202, vcc
    v_cmp_eq_u32 vcc, 0, v4
    v_lshrrev_b32 v200, 2, v3
    v_lshlrev_b32 v200, 5, v200
    v_cndmask_b32 v82, v82, v201, vcc
    v_cmp_gt_u32 vcc, 2, v4
    v_and_b32 v201, 3, v3
    s_nop 0
    v_cndmask_b32 v82, v202, v82, vcc
    v_lshl_add_u32 v200, v201, 2, v200
    s_mul_i32 s4, s52, 640
    s_add_u32 s4, s4, 158720
    v_add_u32 v83, s4, v200
    v_add3_u32 v84, v84, s4, 2
    s_add_u32 m0, s71, 2688
    s_nop 0
    buffer_load_dwordx4 v93, s[8:11], s70 offen offset:384 lds
    s_add_u32 m0, s71, 3584
    s_nop 0
    buffer_load_dwordx4 v93, s[8:11], s70 offen offset:512 lds
    s_mul_i32 s46, s52, 640
    s_add_u32 s46, s46, 22609920
    buffer_load_dwordx4 v[16:19], v74, s[12:15], s46 offen sc1
    buffer_load_dword v32, v74, s[12:15], s46 offen offset:16 sc1
    s_mul_i32 s46, s52, 640
    s_add_u32 s46, s46, 22625280
    buffer_load_dwordx4 v[20:23], v74, s[12:15], s46 offen sc1
    buffer_load_dword v33, v74, s[12:15], s46 offen offset:16 sc1
    s_mul_i32 s46, s52, 640
    s_add_u32 s46, s46, 22640640
    buffer_load_dwordx4 v[24:27], v74, s[12:15], s46 offen sc1
    buffer_load_dword v34, v74, s[12:15], s46 offen offset:16 sc1
    s_mul_i32 s46, s52, 640
    s_add_u32 s46, s46, 22656000
    buffer_load_dwordx4 v[28:31], v74, s[12:15], s46 offen sc1
    buffer_load_dword v35, v74, s[12:15], s46 offen offset:16 sc1
    s_mul_i32 s4, s52, 2560
    s_add_u32 s4, s4, 143360
    v_min_u32 v36, 1, v4
    v_lshlrev_b32 v36, 8, v36
    v_lshl_add_u32 v36, v3, 3, v36
    v_add_u32 v36, s4, v36
    v_lshl_add_u32 v37, v0, 3, s4
    v_lshrrev_b32 v38, 2, v0
    v_lshl_add_u32 v38, v38, 3, s4
    v_and_b32 v200, 3, v0
    v_xor_b32 v201, 0, v200
    v_min_u32 v201, 1, v201
    v_lshl_add_u32 v152, v201, 7, v38
    v_xor_b32 v201, 1, v200
    v_min_u32 v201, 1, v201
    v_lshl_add_u32 v153, v201, 7, v38
    v_xor_b32 v201, 2, v200
    v_min_u32 v201, 1, v201
    v_lshl_add_u32 v154, v201, 7, v38
    v_xor_b32 v201, 3, v200
    v_min_u32 v201, 1, v201
    v_lshl_add_u32 v155, v201, 7, v38
    s_mov_b32 s4, 161280
    v_lshl_add_u32 v65, v3, 2, s4
    v_and_b32 v202, 1, v3
    v_lshl_add_u32 v38, v4, 2, v202
    v_sub_u32 v200, v3, v38
    v_lshl_add_u32 v38, v38, 2, s4
    v_mov_b32 v201, 0xff800000
    v_mov_b32 v204, 0x0c0c0c0c
    v_cmp_eq_u32 s[6:7], 0, v202
    v_cmp_le_i32 vcc, 0, v200
    v_mov_b32 v202, 0xc0c0100
    v_mov_b32 v203, 0x1000c0c
    v_cndmask_b32 v202, v203, v202, s[6:7]
    v_cndmask_b32 v146, v204, v202, vcc
    v_cndmask_b32 v144, v202, v204, vcc
    v_cndmask_b32 v203, 0, 64, vcc
    v_add_u32 v164, v203, v38
    v_cmp_le_i32 vcc, 2, v200
    v_mov_b32 v202, 0xc0c0302
    v_mov_b32 v203, 0x3020c0c
    v_cndmask_b32 v202, v203, v202, s[6:7]
    v_cndmask_b32 v147, v204, v202, vcc
    v_cndmask_b32 v145, v202, v204, vcc
    v_cndmask_b32 v203, 0, 64, vcc
    v_add_u32 v165, v203, v38
    v_bfe_i32 v136, v144, 2, 1
    v_and_b32 v136, v136, v201
    v_bfe_i32 v137, v144, 18, 1
    v_and_b32 v137, v137, v201
    v_bfe_i32 v138, v145, 2, 1
    v_and_b32 v138, v138, v201
    v_bfe_i32 v139, v145, 18, 1
    v_and_b32 v139, v139, v201
    v_bfe_i32 v140, v146, 2, 1
    v_and_b32 v140, v140, v201
    v_bfe_i32 v141, v146, 18, 1
    v_and_b32 v141, v141, v201
    v_bfe_i32 v142, v147, 2, 1
    v_and_b32 v142, v142, v201
    v_bfe_i32 v143, v147, 18, 1
    v_and_b32 v143, v143, v201
    s_cmp_eq_u32 s54, 0
    s_cselect_b64 vcc, -1, 0
    v_cndmask_b32 v148, v136, v201, vcc
    v_cndmask_b32 v149, v137, v201, vcc
    v_cndmask_b32 v150, v138, v201, vcc
    v_cndmask_b32 v151, v139, v201, vcc
    v_and_b32 v39, 31, v0
    v_lshlrev_b32 v39, 4, v39
    v_lshrrev_b32 v38, 5, v0
    v_mul_u32_u24 v38, 20480, v38
    v_add_u32 v39, v39, v38
    v_mul_u32_u24 v38, 20480, v4
    v_lshl_add_u32 v38, v3, 3, v38
    s_mul_i32 s28, s54, 81920
    s_add_u32 s28, s28, 10027008
    s_lshl_b32 s5, s53, 2
    s_add_u32 s5, s5, s52
    s_lshl_b32 s30, s5, 7
    s_add_u32 s30, s30, s28
    s_add_u32 s30, s30, 16384
    s_lshl_b32 s5, s5, 9
    s_add_u32 s28, s28, s5
    s_add_u32 s29, s28, 40960
    s_lshl_b32 s4, s52, 11
    s_lshl_b32 s5, s56, 9
    v_lshl_add_u32 v44, v3, 7, s4
    v_cmp_eq_u32 vcc, 0, v4
    v_and_b32 v45, 3, v0
    v_lshl_add_u32 v45, v45, 7, s5
    v_cndmask_b32 v44, v45, v44, vcc
    v_add_u32 v44, 22712320, v44
    s_waitcnt vmcnt(10)
    ds_read_b64_tr_b16 a[56:57], v56 offset:0
    s_add_u32 s66, s66, 20480
    s_cmp_ge_u32 s66, 102400
    s_cselect_b32 s70, 102400, 0
    s_sub_u32 s66, s66, s70
    s_add_u32 s70, s66, s69
    s_max_i32 s70, s70, 0
    s_add_u32 s70, s70, s67
    s_add_u32 s71, s66, s68
    s_add_u32 m0, s71, 0
    s_nop 0
    buffer_load_dwordx4 v93, s[8:11], s70 offen offset:0 lds
    ds_read_b64_tr_b16 a[58:59], v56 offset:2048
    ds_read_b64_tr_b16 a[60:61], v57 offset:0
    ds_read_b64_tr_b16 a[62:63], v57 offset:2048
    ds_read_b64_tr_b16 a[64:65], v58 offset:0
    ds_read_b64_tr_b16 a[66:67], v58 offset:2048
    ds_read_b64_tr_b16 a[68:69], v59 offset:0
    ds_read_b64_tr_b16 a[70:71], v59 offset:2048
    s_add_u32 m0, s71, 896
    s_nop 0
    buffer_load_dwordx4 v93, s[8:11], s70 offen offset:128 lds
    ds_read_b64_tr_b16 a[72:73], v60 offset:0
    ds_read_b64_tr_b16 a[74:75], v60 offset:2048
    ds_read_b64_tr_b16 a[76:77], v61 offset:0
    ds_read_b64_tr_b16 a[78:79], v61 offset:2048
    ds_read_b64_tr_b16 a[80:81], v62 offset:0
    ds_read_b64_tr_b16 a[82:83], v62 offset:2048
    ds_read_b64_tr_b16 a[84:85], v63 offset:0
    ds_read_b64_tr_b16 a[86:87], v63 offset:2048
    s_and_b32 s47, s58, 0xff
    s_add_u32 m0, s71, 1792
    s_nop 0
    buffer_load_dwordx4 v93, s[8:11], s70 offen offset:256 lds
    s_waitcnt vmcnt(10)
    v_xor_b32 v16, s47, v16
    v_xor_b32 v17, s47, v17
    v_xor_b32 v18, s47, v18
    v_xor_b32 v19, s47, v19
    s_add_u32 m0, s71, 2688
    s_nop 0
    buffer_load_dwordx4 v93, s[8:11], s70 offen offset:384 lds
    s_add_u32 m0, s71, 3584
    s_nop 0
    buffer_load_dwordx4 v93, s[8:11], s70 offen offset:512 lds
    s_waitcnt vmcnt(10)
    v_xor_b32 v20, s47, v20
    v_xor_b32 v21, s47, v21
    v_xor_b32 v22, s47, v22
    v_xor_b32 v23, s47, v23
    s_add_u32 s66, s66, 20480
    s_cmp_ge_u32 s66, 102400
    s_cselect_b32 s70, 102400, 0
    s_sub_u32 s66, s66, s70
    s_add_u32 s70, s66, s69
    s_max_i32 s70, s70, 0
    s_add_u32 s70, s70, s67
    s_add_u32 s71, s66, s68
    s_add_u32 m0, s71, 0
    s_nop 0
    buffer_load_dwordx4 v93, s[8:11], s70 offen offset:0 lds
    s_add_u32 m0, s71, 896
    s_nop 0
    buffer_load_dwordx4 v93, s[8:11], s70 offen offset:128 lds
    s_waitcnt vmcnt(10)
    v_xor_b32 v24, s47, v24
    v_xor_b32 v25, s47, v25
    v_xor_b32 v26, s47, v26
    v_xor_b32 v27, s47, v27
    s_add_u32 m0, s71, 1792
    s_nop 0
    buffer_load_dwordx4 v93, s[8:11], s70 offen offset:256 lds
    s_add_u32 m0, s71, 2688
    s_nop 0
    buffer_load_dwordx4 v93, s[8:11], s70 offen offset:384 lds
    s_waitcnt vmcnt(10)
    v_xor_b32 v28, s47, v28
    v_xor_b32 v29, s47, v29
    v_xor_b32 v30, s47, v30
    v_xor_b32 v31, s47, v31
    v_xor_b32 v32, s47, v32
    v_xor_b32 v33, s47, v33
    v_xor_b32 v34, s47, v34
    buffer_load_dwordx2 v[96:97], v92, s[12:15], s61 offen offset:0 sc1
    s_waitcnt vmcnt(10)
    v_xor_b32 v35, s47, v35
    v_or_b32 v91, v16, v17
    v_or3_b32 v91, v91, v18, v19
    v_or3_b32 v91, v91, v20, v21
    v_or3_b32 v91, v91, v22, v23
    v_or3_b32 v91, v91, v24, v25
    v_or3_b32 v91, v91, v26, v27
    v_or3_b32 v91, v91, v28, v29
    v_or3_b32 v91, v91, v30, v31
    v_or3_b32 v91, v91, v32, v33
    v_or3_b32 v91, v91, v34, v35
    v_and_b32 v91, 0xff, v91
    v_cmp_ne_u32 vcc, 0, v91
    s_cbranch_vccnz L_retry_9
L_back_10:
    v_pk_add_f32 v[16:17], v[16:17], v[20:21]
    v_pk_add_f32 v[18:19], v[18:19], v[22:23]
    buffer_load_dwordx2 v[104:105], v92, s[12:15], s61 offen offset:256 sc1
    v_add_f32 v32, v32, v33
    v_pk_add_f32 v[16:17], v[16:17], v[24:25]
    v_pk_add_f32 v[18:19], v[18:19], v[26:27]
    v_add_f32 v32, v32, v34
    v_pk_add_f32 v[16:17], v[16:17], v[28:29]
    v_pk_add_f32 v[18:19], v[18:19], v[30:31]
    s_load_dwordx8 s[72:79], s[34:35], s62 glc
    v_add_f32 v32, v32, v35
    v_cvt_pk_bf16_f32 v20, v16, v17
    v_cvt_pk_bf16_f32 v21, v18, v19
    v_cvt_pk_bf16_f32 v22, v32, v32
    v_lshlrev_b32 v24, 16, v20
    v_and_b32 v25, 0xffff0000, v20
    v_lshlrev_b32 v26, 16, v21
    v_and_b32 v27, 0xffff0000, v21
    buffer_load_dwordx2 v[112:113], v92, s[12:15], s61 offen offset:512 sc1
    v_lshlrev_b32 v28, 16, v22
    v_add_f32 v24, v75, v24
    v_add_f32 v25, v75, v25
    v_add_f32 v26, v75, v26
    v_add_f32 v27, v75, v27
    v_add_f32 v28, v75, v28
    v_cvt_pk_bf16_f32 v20, v24, v25
    v_cvt_pk_bf16_f32 v21, v26, v27
    v_cvt_pk_bf16_f32 v22, v28, v28
    ds_write_b16 v84, v20 offset:0
    ds_write_b16_d16_hi v84, v20 offset:4
    ds_write_b16 v84, v21 offset:8
    buffer_load_dwordx2 v[120:121], v92, s[12:15], s61 offen offset:768 sc1
    ds_write_b16_d16_hi v84, v21 offset:12
    ds_write_b16 v84, v22 offset:16
    ds_read_b32 v48, v83 offset:0
    ds_read_b32 v49, v83 offset:16
    ds_read_b32 v50, v83 offset:128
    ds_read_b32 v51, v83 offset:144
    ds_read_b32 v52, v83 offset:256
    ds_read_b32 v53, v83 offset:272
    ds_read_b32 v54, v83 offset:384
    ds_read_b32 v55, v83 offset:400
    ds_read_b32 v88, v83 offset:512
    ds_read_b32 v89, v83 offset:528
    s_waitcnt lgkmcnt(9)
    v_perm_b32 v16, v48, v48, v82
    buffer_load_dwordx2 v[128:129], v92, s[12:15], s61 offen offset:1024 sc1
    v_perm_b32 v17, v48, v48, v82
    v_perm_b32 v18, v48, v48, v80
    v_perm_b32 v19, v48, v48, v81
    s_waitcnt lgkmcnt(8)
    v_perm_b32 v20, v49, v49, v80
    s_add_u32 m0, s71, 3584
    s_nop 0
    buffer_load_dwordx4 v93, s[8:11], s70 offen offset:512 lds
    v_perm_b32 v21, v49, v49, v81
    v_perm_b32 v22, v49, v49, v82
    v_perm_b32 v23, v49, v49, v82
    s_add_u32 s66, s66, 20480
    s_cmp_ge_u32 s66, 102400
    s_cselect_b32 s70, 102400, 0
    s_sub_u32 s66, s66, s70
    s_add_u32 s70, s66, s69
    s_max_i32 s70, s70, 0
    s_add_u32 s70, s70, s67
    s_add_u32 s71, s66, s68
    s_add_u32 m0, s71, 0
    s_nop 0
    buffer_load_dwordx4 v93, s[8:11], s70 offen offset:0 lds
    s_add_u32 m0, s71, 896
    s_nop 0
    buffer_load_dwordx4 v93, s[8:11], s70 offen offset:128 lds
    s_add_u32 m0, s71, 1792
    s_nop 0
    buffer_load_dwordx4 v93, s[8:11], s70 offen offset:256 lds
    s_add_u32 m0, s71, 2688
    s_nop 0
    buffer_load_dwordx4 v93, s[8:11], s70 offen offset:384 lds
    s_add_u32 m0, s71, 3584
    s_nop 0
    buffer_load_dwordx4 v93, s[8:11], s70 offen offset:512 lds
    s_mov_b32 s71, 0xffff0000
    s_waitcnt vmcnt(6)
    v_xor_b32 v97, v90, v97
    v_xor_b32 v105, v90, v105
    v_xor_b32 v113, v90, v113
    v_xor_b32 v121, v90, v121
    v_xor_b32 v129, v90, v129
    v_or3_b32 v91, v97, v105, v113
    v_or3_b32 v91, v91, v121, v129
    v_cmp_lt_u32 vcc, 0xffff, v91
    s_cbranch_vccnz L_retry_13
L_back_14:
    v_mov_b64 v[102:103], v[96:97]
    v_mov_b64 v[110:111], v[104:105]
    v_mov_b64 v[118:119], v[112:113]
    v_mov_b64 v[126:127], v[120:121]
    v_mov_b64 v[134:135], v[128:129]
    s_waitcnt lgkmcnt(0)
    s_cmp_lg_u32 s72, s58
    s_cbranch_scc1 L_retry_17
    s_cmp_lg_u32 s73, s58
    s_cbranch_scc1 L_retry_17
    s_cmp_lg_u32 s74, s58
    s_cbranch_scc1 L_retry_17
    s_cmp_lg_u32 s75, s58
    s_cbranch_scc1 L_retry_17
    s_cmp_lg_u32 s76, s58
    s_cbranch_scc1 L_retry_17
L_back_18:
    s_waitcnt vmcnt(0)
    s_barrier
    ds_read_b128 v[98:101], v8 offset:0
    ds_read_b128 v[106:109], v8 offset:20480
    ds_read_b128 v[114:117], v8 offset:40960
    ds_read_b128 v[122:125], v8 offset:61440
    ds_read_b128 v[130:133], v10 offset:0
    ds_read_b128 a[244:247], v12
    ds_read_b128 a[248:251], v13
    ds_read_b64 a[252:253], v14
    s_lshl_b32 s70, s53, 2
    s_add_u32 s70, s70, s52
    s_mul_i32 s70, s70, 76800
    v_xor_b32 v12, 64, v85
    v_add_u32 v14, 61440, v85
    v_add_u32 v15, 61440, v12
    s_waitcnt lgkmcnt(7)
    v_mfma_f32_16x16x32_bf16 v[56:59], v[16:19], v[96:99], 0
    buffer_load_dwordx4 a[88:91], v1, s[12:15], s70 offen offset:0 sc1
    v_mfma_f32_16x16x32_bf16 v[60:63], v[20:23], v[100:103], 0
    buffer_load_dwordx4 a[92:95], v1, s[12:15], s70 offen offset:1024 sc1
    s_waitcnt lgkmcnt(6)
    v_mfma_f32_16x16x32_bf16 v[72:75], v[16:19], v[104:107], 0
    buffer_load_dwordx4 a[96:99], v1, s[12:15], s70 offen offset:2048 sc1
    v_mfma_f32_16x16x32_bf16 v[76:79], v[20:23], v[108:111], 0
    buffer_load_dwordx4 a[100:103], v2, s[12:15], s70 offen offset:3072 sc1
    s_waitcnt lgkmcnt(0)
    s_barrier
    v_cvt_pk_bf16_f32 v98, v56, v57
    v_cvt_pk_bf16_f32 v99, v58, v59
    v_cvt_pk_bf16_f32 v100, v60, v61
    v_cvt_pk_bf16_f32 v101, v62, v63
    v_mfma_f32_16x16x32_bf16 v[56:59], v[16:19], v[112:115], 0
    s_add_u32 s70, s70, 19200
    buffer_load_dwordx4 a[104:107], v1, s[12:15], s70 offen offset:0 sc1
    v_mfma_f32_16x16x32_bf16 v[60:63], v[20:23], v[116:119], 0
    buffer_load_dwordx4 a[108:111], v1, s[12:15], s70 offen offset:1024 sc1
    ds_write_b128 v8, v[98:101] offset:0
    v_cvt_pk_bf16_f32 v106, v72, v73
    v_cvt_pk_bf16_f32 v107, v74, v75
    v_cvt_pk_bf16_f32 v108, v76, v77
    v_cvt_pk_bf16_f32 v109, v78, v79
    v_mfma_f32_16x16x32_bf16 v[72:75], v[16:19], v[120:123], 0
    buffer_load_dwordx4 a[112:115], v1, s[12:15], s70 offen offset:2048 sc1
    v_mfma_f32_16x16x32_bf16 v[76:79], v[20:23], v[124:127], 0
    buffer_load_dwordx4 a[116:119], v2, s[12:15], s70 offen offset:3072 sc1
    ds_write_b128 v8, v[106:109] offset:20480
    v_cvt_pk_bf16_f32 v114, v56, v57
    v_cvt_pk_bf16_f32 v115, v58, v59
    v_cvt_pk_bf16_f32 v116, v60, v61
    v_cvt_pk_bf16_f32 v117, v62, v63
    v_mfma_f32_16x16x32_bf16 v[56:59], v[16:19], v[128:131], 0
    s_add_u32 s70, s70, 19200
    buffer_load_dwordx4 a[120:123], v1, s[12:15], s70 offen offset:0 sc1
    v_mfma_f32_16x16x32_bf16 v[60:63], v[20:23], v[132:135], 0
    ds_write_b128 v8, v[114:117] offset:40960
    v_cvt_pk_bf16_f32 v122, v72, v73
    v_cvt_pk_bf16_f32 v123, v74, v75
    v_cvt_pk_bf16_f32 v124, v76, v77
    v_cvt_pk_bf16_f32 v125, v78, v79
    ds_write_b128 v8, v[122:125] offset:61440
    v_cvt_pk_bf16_f32 v130, v56, v57
    v_cvt_pk_bf16_f32 v131, v58, v59
    v_cvt_pk_bf16_f32 v132, v60, v61
    v_cvt_pk_bf16_f32 v133, v62, v63
    ds_write_b128 v10, v[130:133] offset:0
    s_waitcnt lgkmcnt(0)
    s_barrier
    ds_read_b128 v[16:19], v85 offset:0
    ds_read_b128 v[20:23], v85 offset:20480
    ds_read_b128 v[24:27], v85 offset:40960
    ds_read_b128 v[28:31], v14 offset:0
    ds_read_b128 v[32:35], v14 offset:20480
    s_waitcnt vmcnt(5) lgkmcnt(4)
    v_mfma_f32_16x16x32_bf16 v[196:199], a[92:95], v[16:19], 0
    buffer_load_dwordx4 a[124:127], v1, s[12:15], s70 offen offset:1024 sc1
    v_mfma_f32_16x16x32_bf16 v[216:219], v[16:19], a[96:99], 0
    buffer_load_dwordx4 a[128:131], v1, s[12:15], s70 offen offset:2048 sc1
    v_mfma_f32_16x16x32_bf16 v[236:239], a[100:103], v[16:19], 0
    ds_read_b128 v[16:19], v12 offset:2048
    s_waitcnt lgkmcnt(4)
    v_mfma_f32_16x16x32_bf16 v[180:183], a[88:91], v[20:23], 0
    buffer_load_dwordx4 a[132:135], v2, s[12:15], s70 offen offset:3072 sc1
    v_mfma_f32_16x16x32_bf16 v[200:203], a[92:95], v[20:23], 0
    s_add_u32 s70, s70, 19200
    buffer_load_dwordx4 a[136:139], v1, s[12:15], s70 offen offset:0 sc1
    v_mfma_f32_16x16x32_bf16 v[220:223], v[20:23], a[96:99], 0
    buffer_load_dwordx4 a[140:143], v1, s[12:15], s70 offen offset:1024 sc1
    v_mfma_f32_16x16x32_bf16 v[240:243], a[100:103], v[20:23], 0
    ds_read_b128 v[20:23], v12 offset:22528
    s_waitcnt lgkmcnt(4)
    v_mfma_f32_16x16x32_bf16 v[184:187], a[88:91], v[24:27], 0
    buffer_load_dwordx4 a[144:147], v1, s[12:15], s70 offen offset:2048 sc1
    v_mfma_f32_16x16x32_bf16 v[204:207], a[92:95], v[24:27], 0
    buffer_store_dwordx4 a[56:59], v64, s[12:15], s36 offen sc1
    v_mfma_f32_16x16x32_bf16 v[224:227], v[24:27], a[96:99], 0
    buffer_load_dwordx4 a[148:151], v2, s[12:15], s70 offen offset:3072 sc1
    v_mfma_f32_16x16x32_bf16 v[244:247], a[100:103], v[24:27], 0
    ds_read_b128 v[24:27], v12 offset:43008
    s_waitcnt lgkmcnt(4)
    v_mfma_f32_16x16x32_bf16 v[188:191], a[88:91], v[28:31], 0
    buffer_store_dwordx4 a[60:63], v64, s[12:15], s37 offen sc1
    v_mfma_f32_16x16x32_bf16 v[208:211], a[92:95], v[28:31], 0
    s_sub_u32 s70, s70, 53760
    buffer_load_dwordx4 a[152:155], v1, s[12:15], s70 offen offset:0 sc1
    v_mfma_f32_16x16x32_bf16 v[228:231], v[28:31], a[96:99], 0
    ds_read_b128 v[98:101], v9 offset:0
    ds_read_b128 v[106:109], v9 offset:20480
    v_mfma_f32_16x16x32_bf16 v[248:251], a[100:103], v[28:31], 0
    ds_read_b128 v[28:31], v15 offset:2048
    s_waitcnt lgkmcnt(6)
    v_mfma_f32_16x16x32_bf16 v[192:195], a[88:91], v[32:35], 0
    ds_read_b128 v[114:117], v9 offset:40960
    ds_read_b128 v[122:125], v9 offset:61440
    v_mfma_f32_16x16x32_bf16 v[212:215], a[92:95], v[32:35], 0
    ds_read_b128 v[130:133], v11 offset:0
    v_perm_b32 v176, v50, v50, v82
    v_mfma_f32_16x16x32_bf16 v[232:235], v[32:35], a[96:99], 0
    v_perm_b32 v177, v50, v50, v82
    v_perm_b32 v178, v50, v50, v80
    v_mfma_f32_16x16x32_bf16 v[252:255], a[100:103], v[32:35], 0
    ds_read_b128 v[32:35], v15 offset:22528
    s_waitcnt vmcnt(11) lgkmcnt(9)
    v_mfma_f32_16x16x32_bf16 v[196:199], a[108:111], v[16:19], v[196:199]
    v_perm_b32 v179, v50, v50, v81
    v_perm_b32 v92, v51, v51, v80
    v_mfma_f32_16x16x32_bf16 v[216:219], v[16:19], a[112:115], v[216:219]
    v_perm_b32 v93, v51, v51, v81
    v_perm_b32 v94, v51, v51, v82
    v_mfma_f32_16x16x32_bf16 v[236:239], a[116:119], v[16:19], v[236:239]
    ds_read_b128 v[16:19], v85 offset:5120
    s_waitcnt lgkmcnt(9)
    v_mfma_f32_16x16x32_bf16 v[180:183], a[104:107], v[20:23], v[180:183]
    v_perm_b32 v95, v51, v51, v82
    s_waitcnt lgkmcnt(7)
    v_mfma_f32_16x16x32_bf16 v[56:59], v[176:179], v[96:99], 0
    v_mfma_f32_16x16x32_bf16 v[60:63], v[92:95], v[100:103], 0
    v_mfma_f32_16x16x32_bf16 v[200:203], a[108:111], v[20:23], v[200:203]
    s_lshl_b32 s64, s55, 2
    s_add_u32 s64, s64, s52
    s_mul_i32 s64, s64, 61440
    v_mfma_f32_16x16x32_bf16 v[220:223], v[20:23], a[112:115], v[220:223]
    s_waitcnt lgkmcnt(6)
    v_mfma_f32_16x16x32_bf16 v[72:75], v[176:179], v[104:107], 0
    v_cvt_pk_bf16_f32 v98, v56, v57
    v_cvt_pk_bf16_f32 v99, v58, v59
    v_mfma_f32_16x16x32_bf16 v[76:79], v[92:95], v[108:111], 0
    v_cvt_pk_bf16_f32 v100, v60, v61
    v_cvt_pk_bf16_f32 v101, v62, v63
    v_mfma_f32_16x16x32_bf16 v[240:243], a[116:119], v[20:23], v[240:243]
    ds_read_b128 v[20:23], v85 offset:25600
    v_mfma_f32_16x16x32_bf16 v[184:187], a[104:107], v[24:27], v[184:187]
    buffer_store_dwordx4 a[64:67], v64, s[12:15], s38 offen sc1
    v_mfma_f32_16x16x32_bf16 v[204:207], a[108:111], v[24:27], v[204:207]
    ds_write_b128 v9, v[98:101] offset:0
    v_mfma_f32_16x16x32_bf16 v[224:227], v[24:27], a[112:115], v[224:227]
    s_add_u32 s64, s64, 3342336
    s_mul_i32 s68, s52, 13
    s_lshr_b32 s69, s52, 1
    v_mfma_f32_16x16x32_bf16 v[244:247], a[116:119], v[24:27], v[244:247]
    ds_read_b128 v[24:27], v85 offset:46080
    s_waitcnt lgkmcnt(8)
    v_mfma_f32_16x16x32_bf16 v[188:191], a[104:107], v[28:31], v[188:191]
    buffer_load_dwordx4 a[156:159], v1, s[12:15], s70 offen offset:1024 sc1
    v_mfma_f32_16x16x32_bf16 v[208:211], a[108:111], v[28:31], v[208:211]
    s_add_u32 s69, s69, 39
    s_sub_u32 s69, s69, s68
    s_mul_i32 s65, s53, 54
    v_mfma_f32_16x16x32_bf16 v[228:231], v[28:31], a[112:115], v[228:231]
    buffer_store_dwordx4 a[68:71], v64, s[12:15], s39 offen sc1
    v_mfma_f32_16x16x32_bf16 v[248:251], a[116:119], v[28:31], v[248:251]
    ds_read_b128 v[28:31], v14 offset:5120
    s_waitcnt lgkmcnt(5)
    v_mfma_f32_16x16x32_bf16 v[192:195], a[104:107], v[32:35], v[192:195]
    v_mfma_f32_16x16x32_bf16 v[56:59], v[176:179], v[112:115], 0
    v_cvt_pk_bf16_f32 v106, v72, v73
    v_cvt_pk_bf16_f32 v107, v74, v75
    v_mfma_f32_16x16x32_bf16 v[60:63], v[92:95], v[116:119], 0
    v_cvt_pk_bf16_f32 v108, v76, v77
    v_cvt_pk_bf16_f32 v109, v78, v79
    v_mfma_f32_16x16x32_bf16 v[212:215], a[108:111], v[32:35], v[212:215]
    buffer_load_dwordx4 a[160:163], v1, s[12:15], s70 offen offset:2048 sc1
    v_mfma_f32_16x16x32_bf16 v[232:235], v[32:35], a[112:115], v[232:235]
    ds_write_b128 v9, v[106:109] offset:20480
    v_mfma_f32_16x16x32_bf16 v[252:255], a[116:119], v[32:35], v[252:255]
    ds_read_b128 v[32:35], v14 offset:25600
    s_waitcnt vmcnt(11) lgkmcnt(6)
    v_mfma_f32_16x16x32_bf16 v[196:199], a[124:127], v[16:19], v[196:199]
    buffer_store_dwordx4 a[72:75], v64, s[12:15], s40 offen sc1
    v_mfma_f32_16x16x32_bf16 v[216:219], v[16:19], a[128:131], v[216:219]
    s_add_u32 s65, s65, s68
    s_mul_i32 s65, s65, 5120
    s_add_u32 s65, s65, 7798784
    v_mfma_f32_16x16x32_bf16 v[236:239], a[132:135], v[16:19], v[236:239]
    ds_read_b128 v[16:19], v12 offset:7168
    s_waitcnt lgkmcnt(6)
    v_mfma_f32_16x16x32_bf16 v[180:183], a[120:123], v[20:23], v[180:183]
    buffer_load_dwordx4 a[164:167], v2, s[12:15], s70 offen offset:3072 sc1
    v_mfma_f32_16x16x32_bf16 v[200:203], a[124:127], v[20:23], v[200:203]
    s_mul_i32 s66, s55, 40960
    s_mul_i32 s60, s52, 10240
    s_add_u32 s66, s66, s60
    v_mfma_f32_16x16x32_bf16 v[220:223], v[20:23], a[128:131], v[220:223]
    v_mfma_f32_16x16x32_bf16 v[72:75], v[176:179], v[120:123], 0
    v_cvt_pk_bf16_f32 v114, v56, v57
    v_cvt_pk_bf16_f32 v115, v58, v59
    v_mfma_f32_16x16x32_bf16 v[76:79], v[92:95], v[124:127], 0
    v_cvt_pk_bf16_f32 v116, v60, v61
    v_cvt_pk_bf16_f32 v117, v62, v63
    v_mfma_f32_16x16x32_bf16 v[240:243], a[132:135], v[20:23], v[240:243]
    ds_read_b128 v[20:23], v12 offset:27648
    s_waitcnt lgkmcnt(5)
    v_mfma_f32_16x16x32_bf16 v[184:187], a[120:123], v[24:27], v[184:187]
    buffer_store_dwordx4 a[76:79], v64, s[12:15], s41 offen sc1
    v_mfma_f32_16x16x32_bf16 v[204:207], a[124:127], v[24:27], v[204:207]
    ds_write_b128 v9, v[114:117] offset:40960
    v_mfma_f32_16x16x32_bf16 v[224:227], v[24:27], a[128:131], v[224:227]
    s_add_u32 s66, s66, 7274496
    s_mul_i32 s5, s53, 102400
    s_lshr_b32 s57, s60, 1
    v_mfma_f32_16x16x32_bf16 v[244:247], a[132:135], v[24:27], v[244:247]
    ds_read_b128 v[24:27], v12 offset:48128
    s_waitcnt lgkmcnt(6)
    v_mfma_f32_16x16x32_bf16 v[188:191], a[120:123], v[28:31], v[188:191]
    s_add_u32 s70, s70, 19200
    buffer_load_dwordx4 a[168:171], v1, s[12:15], s70 offen offset:0 sc1
    v_mfma_f32_16x16x32_bf16 v[208:211], a[124:127], v[28:31], v[208:211]
    s_add_u32 s67, s5, s57
    s_add_u32 s67, s67, 2572288
    s_mul_i32 s61, s52, 20480
    v_mfma_f32_16x16x32_bf16 v[228:231], v[28:31], a[128:131], v[228:231]
    v_mfma_f32_16x16x32_bf16 v[56:59], v[176:179], v[128:131], 0
    v_cvt_pk_bf16_f32 v122, v72, v73
    v_cvt_pk_bf16_f32 v123, v74, v75
    v_mfma_f32_16x16x32_bf16 v[60:63], v[92:95], v[132:135], 0
    v_cvt_pk_bf16_f32 v124, v76, v77
    v_cvt_pk_bf16_f32 v125, v78, v79
    v_mfma_f32_16x16x32_bf16 v[248:251], a[132:135], v[28:31], v[248:251]
    ds_read_b128 v[28:31], v15 offset:7168
    s_waitcnt lgkmcnt(5)
    v_mfma_f32_16x16x32_bf16 v[192:195], a[120:123], v[32:35], v[192:195]
    ds_write_b128 v9, v[122:125] offset:61440
    v_mfma_f32_16x16x32_bf16 v[212:215], a[124:127], v[32:35], v[212:215]
    s_add_u32 s62, s5, s61
    s_add_u32 s62, s62, 2490368
    v_mfma_f32_16x16x32_bf16 v[232:235], v[32:35], a[128:131], v[232:235]
    v_add_u32 v5, 20480, v1
    v_add_u32 v6, 40960, v1
    v_mfma_f32_16x16x32_bf16 v[252:255], a[132:135], v[32:35], v[252:255]
    ds_read_b128 v[32:35], v15 offset:27648
    v_cvt_pk_bf16_f32 v130, v56, v57
    v_cvt_pk_bf16_f32 v131, v58, v59
    v_cvt_pk_bf16_f32 v132, v60, v61
    v_cvt_pk_bf16_f32 v133, v62, v63
    ds_write_b128 v11, v[130:133] offset:0
    s_waitcnt lgkmcnt(0)
    s_barrier
    s_waitcnt vmcnt(10)
    v_mfma_f32_16x16x32_bf16 v[196:199], a[140:143], v[16:19], v[196:199]
    buffer_store_dwordx4 a[80:83], v64, s[12:15], s42 offen sc1
    v_mfma_f32_16x16x32_bf16 v[216:219], v[16:19], a[144:147], v[216:219]
    buffer_load_dwordx4 a[172:175], v1, s[12:15], s70 offen offset:1024 sc1
    v_mfma_f32_16x16x32_bf16 v[236:239], a[148:151], v[16:19], v[236:239]
    ds_read_b128 v[16:19], v12 offset:0
    v_mfma_f32_16x16x32_bf16 v[180:183], a[136:139], v[20:23], v[180:183]
    buffer_store_dwordx4 a[84:87], v64, s[12:15], s43 offen sc1
    v_mfma_f32_16x16x32_bf16 v[200:203], a[140:143], v[20:23], v[200:203]
    buffer_load_dwordx4 a[176:179], v1, s[12:15], s70 offen offset:2048 sc1
    v_mfma_f32_16x16x32_bf16 v[220:223], v[20:23], a[144:147], v[220:223]
    ds_read_b128 v[98:101], v8 offset:1024
    ds_read_b128 v[106:109], v8 offset:21504
    v_mfma_f32_16x16x32_bf16 v[240:243], a[148:151], v[20:23], v[240:243]
    ds_read_b128 v[20:23], v12 offset:20480
    v_mfma_f32_16x16x32_bf16 v[184:187], a[136:139], v[24:27], v[184:187]
    ds_read_b128 v[114:117], v8 offset:41984
    ds_read_b128 v[122:125], v8 offset:62464
    v_mfma_f32_16x16x32_bf16 v[204:207], a[140:143], v[24:27], v[204:207]
    buffer_load_dwordx4 a[180:183], v2, s[12:15], s70 offen offset:3072 sc1
    v_mfma_f32_16x16x32_bf16 v[224:227], v[24:27], a[144:147], v[224:227]
    ds_read_b128 v[130:133], v10 offset:1024
    v_perm_b32 v176, v52, v52, v82
    v_mfma_f32_16x16x32_bf16 v[244:247], a[148:151], v[24:27], v[244:247]
    ds_read_b128 v[24:27], v12 offset:40960
    v_mfma_f32_16x16x32_bf16 v[188:191], a[136:139], v[28:31], v[188:191]
    v_perm_b32 v177, v52, v52, v82
    v_perm_b32 v178, v52, v52, v80
    v_mfma_f32_16x16x32_bf16 v[208:211], a[140:143], v[28:31], v[208:211]
    s_add_u32 s70, s70, 19200
    buffer_load_dwordx4 a[184:187], v1, s[12:15], s70 offen offset:0 sc1
    v_mfma_f32_16x16x32_bf16 v[228:231], v[28:31], a[144:147], v[228:231]
    v_perm_b32 v179, v52, v52, v81
    v_perm_b32 v92, v53, v53, v80
    v_mfma_f32_16x16x32_bf16 v[248:251], a[148:151], v[28:31], v[248:251]
    ds_read_b128 v[28:31], v15 offset:0
    v_mfma_f32_16x16x32_bf16 v[192:195], a[136:139], v[32:35], v[192:195]
    v_perm_b32 v93, v53, v53, v81
    v_perm_b32 v94, v53, v53, v82
    v_mfma_f32_16x16x32_bf16 v[212:215], a[140:143], v[32:35], v[212:215]
    v_perm_b32 v95, v53, v53, v82
    s_waitcnt lgkmcnt(7)
    v_mfma_f32_16x16x32_bf16 v[56:59], v[176:179], v[96:99], 0
    v_mfma_f32_16x16x32_bf16 v[60:63], v[92:95], v[100:103], 0
    v_mfma_f32_16x16x32_bf16 v[232:235], v[32:35], a[144:147], v[232:235]
    buffer_load_dwordx4 a[188:191], v1, s[12:15], s70 offen offset:1024 sc1
    v_mfma_f32_16x16x32_bf16 v[252:255], a[148:151], v[32:35], v[252:255]
    ds_read_b128 v[32:35], v15 offset:20480
    s_waitcnt vmcnt(9)
    v_mfma_f32_16x16x32_bf16 v[196:199], a[156:159], v[16:19], v[196:199]
    buffer_load_dwordx4 a[192:195], v1, s[12:15], s70 offen offset:2048 sc1
    v_mfma_f32_16x16x32_bf16 v[216:219], v[16:19], a[160:163], v[216:219]
    s_cmp_ge_u32 s55, 12
    s_cselect_b32 s4, 0x80000000, 0
    v_mfma_f32_16x16x32_bf16 v[236:239], a[164:167], v[16:19], v[236:239]
    ds_read_b128 v[16:19], v85 offset:3072
    s_waitcnt lgkmcnt(7)
    v_mfma_f32_16x16x32_bf16 v[180:183], a[152:155], v[20:23], v[180:183]
    v_mfma_f32_16x16x32_bf16 v[72:75], v[176:179], v[104:107], 0
    v_cvt_pk_bf16_f32 v98, v56, v57
    v_cvt_pk_bf16_f32 v99, v58, v59
    v_mfma_f32_16x16x32_bf16 v[76:79], v[92:95], v[108:111], 0
    v_cvt_pk_bf16_f32 v100, v60, v61
    v_cvt_pk_bf16_f32 v101, v62, v63
    v_mfma_f32_16x16x32_bf16 v[200:203], a[156:159], v[20:23], v[200:203]
    ds_write_b128 v8, v[98:101] offset:1024
    v_mfma_f32_16x16x32_bf16 v[220:223], v[20:23], a[160:163], v[220:223]
    v_or_b32 v7, s4, v1
    s_mul_i32 s4, s69, 5120
    v_mfma_f32_16x16x32_bf16 v[240:243], a[164:167], v[20:23], v[240:243]
    ds_read_b128 v[20:23], v85 offset:23552
    s_waitcnt lgkmcnt(5)
    v_mfma_f32_16x16x32_bf16 v[184:187], a[152:155], v[24:27], v[184:187]
    buffer_load_dwordx4 a[196:199], v2, s[12:15], s70 offen offset:3072 sc1
    v_mfma_f32_16x16x32_bf16 v[204:207], a[156:159], v[24:27], v[204:207]
    v_add_u32 v13, s4, v1
    s_lshl_b32 s69, s69, 10
    v_mfma_f32_16x16x32_bf16 v[224:227], v[24:27], a[160:163], v[224:227]
    v_mfma_f32_16x16x32_bf16 v[56:59], v[176:179], v[112:115], 0
    v_cvt_pk_bf16_f32 v106, v72, v73
    v_cvt_pk_bf16_f32 v107, v74, v75
    v_mfma_f32_16x16x32_bf16 v[60:63], v[92:95], v[116:119], 0
    v_cvt_pk_bf16_f32 v108, v76, v77
    v_cvt_pk_bf16_f32 v109, v78, v79
    v_mfma_f32_16x16x32_bf16 v[244:247], a[164:167], v[24:27], v[244:247]
    ds_read_b128 v[24:27], v85 offset:44032
    s_waitcnt lgkmcnt(5)
    v_mfma_f32_16x16x32_bf16 v[188:191], a[152:155], v[28:31], v[188:191]
    s_add_u32 s70, s70, 19200
    buffer_load_dwordx4 a[200:203], v1, s[12:15], s70 offen offset:0 sc1
    v_mfma_f32_16x16x32_bf16 v[208:211], a[156:159], v[28:31], v[208:211]
    buffer_load_dwordx4 a[204:207], v1, s[12:15], s70 offen offset:1024 sc1
    v_mfma_f32_16x16x32_bf16 v[228:231], v[28:31], a[160:163], v[228:231]
    ds_write_b128 v8, v[106:109] offset:21504
    v_mfma_f32_16x16x32_bf16 v[248:251], a[164:167], v[28:31], v[248:251]
    ds_read_b128 v[28:31], v14 offset:3072
    s_waitcnt lgkmcnt(6)
    v_mfma_f32_16x16x32_bf16 v[192:195], a[152:155], v[32:35], v[192:195]
    v_lshlrev_b32 v46, 16, v96
    v_and_b32 v47, s71, v96
    v_mfma_f32_16x16x32_bf16 v[212:215], a[156:159], v[32:35], v[212:215]
    buffer_load_dwordx4 a[208:211], v1, s[12:15], s70 offen offset:2048 sc1
    v_mfma_f32_16x16x32_bf16 v[232:235], v[32:35], a[160:163], v[232:235]
    v_add_f32 v46, v46, v47
    v_lshlrev_b32 v47, 16, v97
    v_mfma_f32_16x16x32_bf16 v[252:255], a[164:167], v[32:35], v[252:255]
    ds_read_b128 v[32:35], v14 offset:23552
    buffer_load_dwordx4 a[212:215], v2, s[12:15], s70 offen offset:3072 sc1
    s_sub_u32 s70, s70, 53760
    buffer_load_dwordx4 a[216:219], v1, s[12:15], s70 offen offset:0 sc1
    buffer_load_dwordx4 a[220:223], v1, s[12:15], s70 offen offset:1024 sc1
    s_waitcnt vmcnt(10) lgkmcnt(6)
    v_mfma_f32_16x16x32_bf16 v[196:199], a[172:175], v[16:19], v[196:199]
    v_mfma_f32_16x16x32_bf16 v[72:75], v[176:179], v[120:123], 0
    v_cvt_pk_bf16_f32 v114, v56, v57
    v_cvt_pk_bf16_f32 v115, v58, v59
    v_mfma_f32_16x16x32_bf16 v[76:79], v[92:95], v[124:127], 0
    v_cvt_pk_bf16_f32 v116, v60, v61
    v_cvt_pk_bf16_f32 v117, v62, v63
    v_mfma_f32_16x16x32_bf16 v[216:219], v[16:19], a[176:179], v[216:219]
    ds_write_b128 v8, v[114:117] offset:41984
    v_mfma_f32_16x16x32_bf16 v[236:239], a[180:183], v[16:19], v[236:239]
    ds_read_b128 v[16:19], v12 offset:5120
    s_waitcnt lgkmcnt(6)
    v_mfma_f32_16x16x32_bf16 v[180:183], a[168:171], v[20:23], v[180:183]
    buffer_load_dwordx4 a[224:227], v1, s[12:15], s70 offen offset:2048 sc1
    v_mfma_f32_16x16x32_bf16 v[200:203], a[172:175], v[20:23], v[200:203]
    v_add_f32 v46, v46, v47
    v_mfma_f32_16x16x32_bf16 v[220:223], v[20:23], a[176:179], v[220:223]
    buffer_load_dwordx4 a[228:231], v2, s[12:15], s70 offen offset:3072 sc1
    v_mfma_f32_16x16x32_bf16 v[240:243], a[180:183], v[20:23], v[240:243]
    ds_read_b128 v[20:23], v12 offset:25600
    s_waitcnt lgkmcnt(6)
    v_mfma_f32_16x16x32_bf16 v[184:187], a[168:171], v[24:27], v[184:187]
    v_rcp_f32 v46, v46
    v_mfma_f32_16x16x32_bf16 v[204:207], a[172:175], v[24:27], v[204:207]
    v_mfma_f32_16x16x32_bf16 v[56:59], v[176:179], v[128:131], 0
    v_cvt_pk_bf16_f32 v122, v72, v73
    v_cvt_pk_bf16_f32 v123, v74, v75
    v_mfma_f32_16x16x32_bf16 v[60:63], v[92:95], v[132:135], 0
    v_cvt_pk_bf16_f32 v124, v76, v77
    v_cvt_pk_bf16_f32 v125, v78, v79
    v_mfma_f32_16x16x32_bf16 v[224:227], v[24:27], a[176:179], v[224:227]
    s_add_u32 s70, s70, 19200
    buffer_load_dwordx4 a[232:235], v1, s[12:15], s70 offen offset:0 sc1
    v_mfma_f32_16x16x32_bf16 v[244:247], a[180:183], v[24:27], v[244:247]
    ds_read_b128 v[24:27], v12 offset:46080
    s_waitcnt lgkmcnt(5)
    v_mfma_f32_16x16x32_bf16 v[188:191], a[168:171], v[28:31], v[188:191]
    ds_write_b128 v8, v[122:125] offset:62464
    v_mfma_f32_16x16x32_bf16 v[208:211], a[172:175], v[28:31], v[208:211]
    buffer_load_dwordx4 a[236:239], v1, s[12:15], s70 offen offset:1024 sc1
    v_mfma_f32_16x16x32_bf16 v[228:231], v[28:31], a[176:179], v[228:231]
    s_mov_b32 exec_lo, s71
    s_mov_b32 exec_hi, 0
    ds_write_b32 v65, v46 offset:0
    s_mov_b64 exec, -1
    v_mfma_f32_16x16x32_bf16 v[248:251], a[180:183], v[28:31], v[248:251]
    ds_read_b128 v[28:31], v15 offset:5120
    s_waitcnt lgkmcnt(7)
    v_mfma_f32_16x16x32_bf16 v[192:195], a[168:171], v[32:35], v[192:195]
    v_lshlrev_b32 v46, 16, v104
    v_and_b32 v47, s71, v104
    v_mfma_f32_16x16x32_bf16 v[212:215], a[172:175], v[32:35], v[212:215]
    buffer_load_dwordx4 a[240:243], v1, s[12:15], s70 offen offset:2048 sc1
    v_mfma_f32_16x16x32_bf16 v[232:235], v[32:35], a[176:179], v[232:235]
    v_add_f32 v46, v46, v47
    v_lshlrev_b32 v47, 16, v105
    v_mfma_f32_16x16x32_bf16 v[252:255], a[180:183], v[32:35], v[252:255]
    ds_read_b128 v[32:35], v15 offset:25600
    s_barrier
    s_cmp_eq_u32 s52, 0
    s_cbranch_scc0 L_else_21
    s_atomic_swap s63, s[0:1], 0x9000
L_else_21:
    s_waitcnt vmcnt(11) lgkmcnt(6)
    v_mfma_f32_16x16x32_bf16 v[196:199], a[188:191], v[16:19], v[196:199]
    buffer_load_dwordx4 a[0:3], v2, s[12:15], s70 offen offset:3072 sc1
    v_mfma_f32_16x16x32_bf16 v[216:219], v[16:19], a[192:195], v[216:219]
    v_cvt_pk_bf16_f32 v130, v56, v57
    v_cvt_pk_bf16_f32 v131, v58, v59
    v_mfma_f32_16x16x32_bf16 v[236:239], a[196:199], v[16:19], v[236:239]
    ds_read_b128 v[16:19], v85 offset:8192
    s_waitcnt lgkmcnt(6)
    v_mfma_f32_16x16x32_bf16 v[180:183], a[184:187], v[20:23], v[180:183]
    v_add_f32 v46, v46, v47
    v_mfma_f32_16x16x32_bf16 v[200:203], a[188:191], v[20:23], v[200:203]
    s_add_u32 s70, s70, 19200
    buffer_load_dwordx4 a[4:7], v1, s[12:15], s70 offen offset:0 sc1
    v_mfma_f32_16x16x32_bf16 v[220:223], v[20:23], a[192:195], v[220:223]
    v_cvt_pk_bf16_f32 v132, v60, v61
    v_cvt_pk_bf16_f32 v133, v62, v63
    v_mfma_f32_16x16x32_bf16 v[240:243], a[196:199], v[20:23], v[240:243]
    ds_read_b128 v[20:23], v85 offset:28672
    s_waitcnt lgkmcnt(6)
    v_mfma_f32_16x16x32_bf16 v[184:187], a[184:187], v[24:27], v[184:187]
    buffer_load_dwordx4 a[8:11], v1, s[12:15], s70 offen offset:1024 sc1
    v_mfma_f32_16x16x32_bf16 v[204:207], a[188:191], v[24:27], v[204:207]
    ds_write_b128 v10, v[130:133] offset:1024
    v_mfma_f32_16x16x32_bf16 v[224:227], v[24:27], a[192:195], v[224:227]
    v_rcp_f32 v46, v46
    v_mfma_f32_16x16x32_bf16 v[244:247], a[196:199], v[24:27], v[244:247]
    ds_read_b128 v[24:27], v85 offset:49152
    s_waitcnt lgkmcnt(5)
    v_mfma_f32_16x16x32_bf16 v[188:191], a[184:187], v[28:31], v[188:191]
    buffer_load_dwordx4 a[12:15], v1, s[12:15], s70 offen offset:2048 sc1
    v_mfma_f32_16x16x32_bf16 v[208:211], a[188:191], v[28:31], v[208:211]
    s_mov_b32 exec_lo, s71
    s_mov_b32 exec_hi, 0
    ds_write_b32 v65, v46 offset:64
    s_mov_b64 exec, -1
    v_mfma_f32_16x16x32_bf16 v[228:231], v[28:31], a[192:195], v[228:231]
    v_lshlrev_b32 v46, 16, v112
    v_and_b32 v47, s71, v112
    v_mfma_f32_16x16x32_bf16 v[248:251], a[196:199], v[28:31], v[248:251]
    ds_read_b128 v[28:31], v14 offset:8192
    s_waitcnt lgkmcnt(6)
    v_mfma_f32_16x16x32_bf16 v[192:195], a[184:187], v[32:35], v[192:195]
    v_add_f32 v46, v46, v47
    v_lshlrev_b32 v47, 16, v113
    v_mfma_f32_16x16x32_bf16 v[212:215], a[188:191], v[32:35], v[212:215]
    buffer_load_dwordx4 a[16:19], v2, s[12:15], s70 offen offset:3072 sc1
    v_mfma_f32_16x16x32_bf16 v[232:235], v[32:35], a[192:195], v[232:235]
    v_add_f32 v46, v46, v47
    v_mfma_f32_16x16x32_bf16 v[252:255], a[196:199], v[32:35], v[252:255]
    ds_read_b128 v[32:35], v14 offset:28672
    s_waitcnt lgkmcnt(4)
    s_barrier
    s_waitcnt vmcnt(12)
    v_mfma_f32_16x16x32_bf16 v[196:199], a[204:207], v[16:19], v[196:199]
    s_add_u32 s70, s70, 19200
    buffer_load_dwordx4 a[20:23], v1, s[12:15], s70 offen offset:0 sc1
    v_mfma_f32_16x16x32_bf16 v[216:219], v[16:19], a[208:211], v[216:219]
    ds_read_b128 v[98:101], v9 offset:1024
    ds_read_b128 v[106:109], v9 offset:21504
    v_mfma_f32_16x16x32_bf16 v[236:239], a[212:215], v[16:19], v[236:239]
    ds_read_b128 v[16:19], v85 offset:1024
    v_mfma_f32_16x16x32_bf16 v[180:183], a[200:203], v[20:23], v[180:183]
    ds_read_b128 v[114:117], v9 offset:41984
    ds_read_b128 v[122:125], v9 offset:62464
    v_mfma_f32_16x16x32_bf16 v[200:203], a[204:207], v[20:23], v[200:203]
    ds_read_b128 v[130:133], v11 offset:1024
    v_perm_b32 v176, v54, v54, v82
    v_mfma_f32_16x16x32_bf16 v[220:223], v[20:23], a[208:211], v[220:223]
    buffer_load_dwordx4 a[24:27], v1, s[12:15], s70 offen offset:1024 sc1
    v_mfma_f32_16x16x32_bf16 v[240:243], a[212:215], v[20:23], v[240:243]
    ds_read_b128 v[20:23], v85 offset:21504
    s_waitcnt lgkmcnt(10)
    v_mfma_f32_16x16x32_bf16 v[184:187], a[200:203], v[24:27], v[184:187]
    v_perm_b32 v177, v54, v54, v82
    v_perm_b32 v178, v54, v54, v80
    v_mfma_f32_16x16x32_bf16 v[204:207], a[204:207], v[24:27], v[204:207]
    v_perm_b32 v179, v54, v54, v81
    v_perm_b32 v92, v55, v55, v80
    v_mfma_f32_16x16x32_bf16 v[224:227], v[24:27], a[208:211], v[224:227]
    buffer_load_dwordx4 a[28:31], v1, s[12:15], s70 offen offset:2048 sc1
    v_mfma_f32_16x16x32_bf16 v[244:247], a[212:215], v[24:27], v[244:247]
    ds_read_b128 v[24:27], v85 offset:41984
    s_waitcnt lgkmcnt(9)
    v_mfma_f32_16x16x32_bf16 v[188:191], a[200:203], v[28:31], v[188:191]
    v_perm_b32 v93, v55, v55, v81
    v_perm_b32 v94, v55, v55, v82
    v_mfma_f32_16x16x32_bf16 v[208:211], a[204:207], v[28:31], v[208:211]
    v_perm_b32 v95, v55, v55, v82
    s_waitcnt lgkmcnt(7)
    v_mfma_f32_16x16x32_bf16 v[56:59], v[176:179], v[96:99], 0
    v_mfma_f32_16x16x32_bf16 v[60:63], v[92:95], v[100:103], 0
    v_mfma_f32_16x16x32_bf16 v[228:231], v[28:31], a[208:211], v[228:231]
    buffer_load_dwordx4 a[32:35], v2, s[12:15], s70 offen offset:3072 sc1
    v_mfma_f32_16x16x32_bf16 v[248:251], a[212:215], v[28:31], v[248:251]
    ds_read_b128 v[28:31], v14 offset:1024
    v_mfma_f32_16x16x32_bf16 v[192:195], a[200:203], v[32:35], v[192:195]
    s_sub_u32 s70, s70, 53760
    buffer_load_dwordx4 a[36:39], v1, s[12:15], s70 offen offset:0 sc1
    v_mfma_f32_16x16x32_bf16 v[212:215], a[204:207], v[32:35], v[212:215]
    buffer_load_dword v87, v86, s[12:15], 0 offen
    v_mfma_f32_16x16x32_bf16 v[232:235], v[32:35], a[208:211], v[232:235]
    s_waitcnt lgkmcnt(7)
    v_mfma_f32_16x16x32_bf16 v[72:75], v[176:179], v[104:107], 0
    v_cvt_pk_bf16_f32 v98, v56, v57
    v_cvt_pk_bf16_f32 v99, v58, v59
    v_mfma_f32_16x16x32_bf16 v[76:79], v[92:95], v[108:111], 0
    v_cvt_pk_bf16_f32 v100, v60, v61
    v_cvt_pk_bf16_f32 v101, v62, v63
    v_mfma_f32_16x16x32_bf16 v[252:255], a[212:215], v[32:35], v[252:255]
    ds_read_b128 v[32:35], v14 offset:21504
    s_waitcnt vmcnt(14) lgkmcnt(7)
    v_mfma_f32_16x16x32_bf16 v[196:199], a[220:223], v[16:19], v[196:199]
    ds_write_b128 v9, v[98:101] offset:1024
    v_mfma_f32_16x16x32_bf16 v[216:219], v[16:19], a[224:227], v[216:219]
    v_rcp_f32 v46, v46
    v_mfma_f32_16x16x32_bf16 v[236:239], a[228:231], v[16:19], v[236:239]
    ds_read_b128 v[16:19], v12 offset:3072
    s_waitcnt lgkmcnt(5)
    v_mfma_f32_16x16x32_bf16 v[180:183], a[216:219], v[20:23], v[180:183]
    buffer_load_dwordx4 a[40:43], v1, s[12:15], s70 offen offset:1024 sc1
    v_mfma_f32_16x16x32_bf16 v[200:203], a[220:223], v[20:23], v[200:203]
    s_mov_b32 exec_lo, s71
    s_mov_b32 exec_hi, 0
    ds_write_b32 v65, v46 offset:128
    s_mov_b64 exec, -1
    v_mfma_f32_16x16x32_bf16 v[220:223], v[20:23], a[224:227], v[220:223]
    v_mfma_f32_16x16x32_bf16 v[56:59], v[176:179], v[112:115], 0
    v_cvt_pk_bf16_f32 v106, v72, v73
    v_cvt_pk_bf16_f32 v107, v74, v75
    v_mfma_f32_16x16x32_bf16 v[60:63], v[92:95], v[116:119], 0
    v_cvt_pk_bf16_f32 v108, v76, v77
    v_cvt_pk_bf16_f32 v109, v78, v79
    v_mfma_f32_16x16x32_bf16 v[240:243], a[228:231], v[20:23], v[240:243]
    ds_read_b128 v[20:23], v12 offset:23552
    s_waitcnt lgkmcnt(6)
    v_mfma_f32_16x16x32_bf16 v[184:187], a[216:219], v[24:27], v[184:187]
    buffer_load_dwordx4 a[44:47], v1, s[12:15], s70 offen offset:2048 sc1
    v_mfma_f32_16x16x32_bf16 v[204:207], a[220:223], v[24:27], v[204:207]
    buffer_load_dwordx4 a[48:51], v2, s[12:15], s70 offen offset:3072 sc1
    v_mfma_f32_16x16x32_bf16 v[224:227], v[24:27], a[224:227], v[224:227]
    ds_write_b128 v9, v[106:109] offset:21504
    v_mfma_f32_16x16x32_bf16 v[244:247], a[228:231], v[24:27], v[244:247]
    ds_read_b128 v[24:27], v12 offset:44032
    s_waitcnt lgkmcnt(7)
    v_mfma_f32_16x16x32_bf16 v[188:191], a[216:219], v[28:31], v[188:191]
    v_lshlrev_b32 v46, 16, v120
    v_and_b32 v47, s71, v120
    v_mfma_f32_16x16x32_bf16 v[208:211], a[220:223], v[28:31], v[208:211]
    s_add_u32 s70, s70, 19200
    buffer_load_dwordx4 a[52:55], v1, s[12:15], s70 offen offset:0 sc1
    v_mfma_f32_16x16x32_bf16 v[228:231], v[28:31], a[224:227], v[228:231]
    v_add_f32 v46, v46, v47
    v_lshlrev_b32 v47, 16, v121
    v_mfma_f32_16x16x32_bf16 v[248:251], a[228:231], v[28:31], v[248:251]
    ds_read_b128 v[28:31], v15 offset:3072
    s_waitcnt lgkmcnt(7)
    v_mfma_f32_16x16x32_bf16 v[192:195], a[216:219], v[32:35], v[192:195]
    v_mfma_f32_16x16x32_bf16 v[72:75], v[176:179], v[120:123], 0
    v_cvt_pk_bf16_f32 v114, v56, v57
    v_cvt_pk_bf16_f32 v115, v58, v59
    v_mfma_f32_16x16x32_bf16 v[76:79], v[92:95], v[124:127], 0
    v_cvt_pk_bf16_f32 v116, v60, v61
    v_cvt_pk_bf16_f32 v117, v62, v63
    v_mfma_f32_16x16x32_bf16 v[212:215], a[220:223], v[32:35], v[212:215]
    buffer_load_dwordx4 a[56:59], v1, s[12:15], s70 offen offset:1024 sc1
    v_mfma_f32_16x16x32_bf16 v[232:235], v[32:35], a[224:227], v[232:235]
    ds_write_b128 v9, v[114:117] offset:41984
    v_mfma_f32_16x16x32_bf16 v[252:255], a[228:231], v[32:35], v[252:255]
    ds_read_b128 v[32:35], v15 offset:23552
    s_waitcnt vmcnt(15) lgkmcnt(7)
    v_mfma_f32_16x16x32_bf16 v[196:199], a[236:239], v[16:19], v[196:199]
    buffer_load_dwordx4 a[60:63], v1, s[12:15], s70 offen offset:2048 sc1
    v_mfma_f32_16x16x32_bf16 v[216:219], v[16:19], a[240:243], v[216:219]
    v_add_f32 v46, v46, v47
    v_mfma_f32_16x16x32_bf16 v[236:239], a[0:3], v[16:19], v[236:239]
    ds_read_b128 v[16:19], v85 offset:6144
    s_waitcnt lgkmcnt(6)
    v_mfma_f32_16x16x32_bf16 v[180:183], a[232:235], v[20:23], v[180:183]
    buffer_load_dwordx4 a[88:91], v2, s[12:15], s70 offen offset:3072 sc1
    v_mfma_f32_16x16x32_bf16 v[200:203], a[236:239], v[20:23], v[200:203]
    v_rcp_f32 v46, v46
    v_mfma_f32_16x16x32_bf16 v[220:223], v[20:23], a[240:243], v[220:223]
    v_mfma_f32_16x16x32_bf16 v[56:59], v[176:179], v[128:131], 0
    v_cvt_pk_bf16_f32 v122, v72, v73
    v_cvt_pk_bf16_f32 v123, v74, v75
    v_mfma_f32_16x16x32_bf16 v[60:63], v[92:95], v[132:135], 0
    v_cvt_pk_bf16_f32 v124, v76, v77
    v_cvt_pk_bf16_f32 v125, v78, v79
    v_mfma_f32_16x16x32_bf16 v[240:243], a[0:3], v[20:23], v[240:243]
    ds_read_b128 v[20:23], v85 offset:26624
    s_waitcnt lgkmcnt(5)
    v_mfma_f32_16x16x32_bf16 v[184:187], a[232:235], v[24:27], v[184:187]
    s_add_u32 s70, s70, 19200
    buffer_load_dwordx4 a[92:95], v1, s[12:15], s70 offen offset:0 sc1
    v_mfma_f32_16x16x32_bf16 v[204:207], a[236:239], v[24:27], v[204:207]
    ds_write_b128 v9, v[122:125] offset:62464
    v_mfma_f32_16x16x32_bf16 v[224:227], v[24:27], a[240:243], v[224:227]
    buffer_load_dwordx4 a[96:99], v1, s[12:15], s70 offen offset:1024 sc1
    v_mfma_f32_16x16x32_bf16 v[244:247], a[0:3], v[24:27], v[244:247]
    ds_read_b128 v[24:27], v85 offset:47104
    s_waitcnt lgkmcnt(6)
    v_mfma_f32_16x16x32_bf16 v[188:191], a[232:235], v[28:31], v[188:191]
    s_mov_b32 exec_lo, s71
    s_mov_b32 exec_hi, 0
    ds_write_b32 v65, v46 offset:192
    s_mov_b64 exec, -1
    v_mfma_f32_16x16x32_bf16 v[208:211], a[236:239], v[28:31], v[208:211]
    v_lshlrev_b32 v46, 16, v128
    v_and_b32 v47, s71, v128
    v_mfma_f32_16x16x32_bf16 v[228:231], v[28:31], a[240:243], v[228:231]
    v_add_f32 v46, v46, v47
    v_lshlrev_b32 v47, 16, v129
    v_mfma_f32_16x16x32_bf16 v[248:251], a[0:3], v[28:31], v[248:251]
    ds_read_b128 v[28:31], v14 offset:6144
    s_waitcnt lgkmcnt(6)
    v_mfma_f32_16x16x32_bf16 v[192:195], a[232:235], v[32:35], v[192:195]
    buffer_load_dwordx4 a[100:103], v1, s[12:15], s70 offen offset:2048 sc1
    v_mfma_f32_16x16x32_bf16 v[212:215], a[236:239], v[32:35], v[212:215]
    v_cvt_pk_bf16_f32 v130, v56, v57
    v_cvt_pk_bf16_f32 v131, v58, v59
    v_mfma_f32_16x16x32_bf16 v[232:235], v[32:35], a[240:243], v[232:235]
    buffer_load_dwordx4 a[64:67], v2, s[12:15], s70 offen offset:3072 sc1
    v_mfma_f32_16x16x32_bf16 v[252:255], a[0:3], v[32:35], v[252:255]
    ds_read_b128 v[32:35], v14 offset:26624
    s_waitcnt vmcnt(17) lgkmcnt(6)
    v_mfma_f32_16x16x32_bf16 v[196:199], a[8:11], v[16:19], v[196:199]
    v_add_f32 v46, v46, v47
    v_mfma_f32_16x16x32_bf16 v[216:219], v[16:19], a[12:15], v[216:219]
    v_cvt_pk_bf16_f32 v132, v60, v61
    v_cvt_pk_bf16_f32 v133, v62, v63
    v_mfma_f32_16x16x32_bf16 v[236:239], a[16:19], v[16:19], v[236:239]
    ds_read_b128 v[16:19], v12 offset:8192
    s_waitcnt lgkmcnt(6)
    v_mfma_f32_16x16x32_bf16 v[180:183], a[4:7], v[20:23], v[180:183]
    s_add_u32 s70, s70, 19200
    buffer_load_dwordx4 a[68:71], v1, s[12:15], s70 offen offset:0 sc1
    v_mfma_f32_16x16x32_bf16 v[200:203], a[8:11], v[20:23], v[200:203]
    ds_write_b128 v11, v[130:133] offset:1024
    v_mfma_f32_16x16x32_bf16 v[220:223], v[20:23], a[12:15], v[220:223]
    v_rcp_f32 v46, v46
    v_mfma_f32_16x16x32_bf16 v[240:243], a[16:19], v[20:23], v[240:243]
    ds_read_b128 v[20:23], v12 offset:28672
    s_waitcnt lgkmcnt(6)
    v_mfma_f32_16x16x32_bf16 v[184:187], a[4:7], v[24:27], v[184:187]
    buffer_load_dwordx4 a[104:107], v1, s[12:15], s70 offen offset:1024 sc1
    v_mfma_f32_16x16x32_bf16 v[204:207], a[8:11], v[24:27], v[204:207]
    s_mov_b32 exec_lo, s71
    s_mov_b32 exec_hi, 0
    ds_write_b32 v65, v46 offset:256
    s_mov_b64 exec, -1
    v_mfma_f32_16x16x32_bf16 v[224:227], v[24:27], a[12:15], v[224:227]
    buffer_load_dwordx4 a[108:111], v1, s[12:15], s70 offen offset:2048 sc1
    v_mfma_f32_16x16x32_bf16 v[244:247], a[16:19], v[24:27], v[244:247]
    ds_read_b128 v[24:27], v12 offset:49152
    s_waitcnt lgkmcnt(6)
    v_mfma_f32_16x16x32_bf16 v[188:191], a[4:7], v[28:31], v[188:191]
    ds_read_b32 v172, v65 offset:64
    ds_read_b32 v173, v65 offset:128
    v_mfma_f32_16x16x32_bf16 v[208:211], a[8:11], v[28:31], v[208:211]
    ds_read_b32 v174, v65 offset:192
    ds_read_b32 v175, v65 offset:256
    v_mfma_f32_16x16x32_bf16 v[228:231], v[28:31], a[12:15], v[228:231]
    ds_read_b32 v156, v164 offset:0
    ds_read_b32 v158, v164 offset:64
    v_mfma_f32_16x16x32_bf16 v[248:251], a[16:19], v[28:31], v[248:251]
    ds_read_b128 v[28:31], v15 offset:8192
    s_waitcnt lgkmcnt(12)
    v_mfma_f32_16x16x32_bf16 v[192:195], a[4:7], v[32:35], v[192:195]
    buffer_load_dwordx4 a[112:115], v2, s[12:15], s70 offen offset:3072 sc1
    v_mfma_f32_16x16x32_bf16 v[212:215], a[8:11], v[32:35], v[212:215]
    ds_read_b32 v160, v164 offset:128
    ds_read_b32 v162, v164 offset:192
    v_mfma_f32_16x16x32_bf16 v[232:235], v[32:35], a[12:15], v[232:235]
    s_sub_u32 s70, s70, 53760
    buffer_load_dwordx4 a[116:119], v1, s[12:15], s70 offen offset:0 sc1
    v_mfma_f32_16x16x32_bf16 v[252:255], a[16:19], v[32:35], v[252:255]
    ds_read_b128 v[32:35], v15 offset:28672
    s_waitcnt lgkmcnt(13)
    s_barrier
    s_waitcnt vmcnt(18)
    v_mfma_f32_16x16x32_bf16 v[196:199], a[24:27], v[16:19], v[196:199]
    ds_read_b128 v[98:101], v8 offset:2048
    ds_read_b128 v[106:109], v8 offset:22528
    v_mfma_f32_16x16x32_bf16 v[216:219], v[16:19], a[28:31], v[216:219]
    ds_read_b128 v[114:117], v8 offset:43008
    ds_read_b128 v[122:125], v8 offset:63488
    v_mfma_f32_16x16x32_bf16 v[236:239], a[32:35], v[16:19], v[236:239]
    ds_read_b128 v[16:19], v12 offset:1024
    s_waitcnt lgkmcnt(15)
    v_mfma_f32_16x16x32_bf16 v[180:183], a[20:23], v[20:23], v[180:183]
    ds_read_b128 v[130:133], v10 offset:2048
    v_perm_b32 v176, v88, v88, v82
    v_mfma_f32_16x16x32_bf16 v[200:203], a[24:27], v[20:23], v[200:203]
    buffer_load_dwordx4 a[72:75], v1, s[12:15], s70 offen offset:1024 sc1
    v_mfma_f32_16x16x32_bf16 v[220:223], v[20:23], a[28:31], v[220:223]
    v_perm_b32 v177, v88, v88, v82
    v_perm_b32 v178, v88, v88, v80
    v_mfma_f32_16x16x32_bf16 v[240:243], a[32:35], v[20:23], v[240:243]
    ds_read_b128 v[20:23], v12 offset:21504
    v_mfma_f32_16x16x32_bf16 v[184:187], a[20:23], v[24:27], v[184:187]
    v_perm_b32 v179, v88, v88, v81
    v_perm_b32 v92, v89, v89, v80
    v_mfma_f32_16x16x32_bf16 v[204:207], a[24:27], v[24:27], v[204:207]
    buffer_load_dwordx4 a[76:79], v1, s[12:15], s70 offen offset:2048 sc1
    v_mfma_f32_16x16x32_bf16 v[224:227], v[24:27], a[28:31], v[224:227]
    v_perm_b32 v93, v89, v89, v81
    v_perm_b32 v94, v89, v89, v82
    v_mfma_f32_16x16x32_bf16 v[244:247], a[32:35], v[24:27], v[244:247]
    ds_read_b128 v[24:27], v12 offset:41984
    s_waitcnt lgkmcnt(11)
    v_mfma_f32_16x16x32_bf16 v[188:191], a[20:23], v[28:31], v[188:191]
    buffer_load_dwordx4 a[120:123], v2, s[12:15], s70 offen offset:3072 sc1
    v_mfma_f32_16x16x32_bf16 v[208:211], a[24:27], v[28:31], v[208:211]
    v_perm_b32 v95, v89, v89, v82
    s_waitcnt lgkmcnt(7)
    v_mfma_f32_16x16x32_bf16 v[56:59], v[176:179], v[96:99], 0
    v_mfma_f32_16x16x32_bf16 v[60:63], v[92:95], v[100:103], 0
    v_mfma_f32_16x16x32_bf16 v[228:231], v[28:31], a[28:31], v[228:231]
    s_add_u32 s70, s70, 19200
    buffer_load_dwordx4 a[124:127], v1, s[12:15], s70 offen offset:0 sc1
    v_mfma_f32_16x16x32_bf16 v[248:251], a[32:35], v[28:31], v[248:251]
    ds_read_b128 v[28:31], v15 offset:1024
    v_mfma_f32_16x16x32_bf16 v[192:195], a[20:23], v[32:35], v[192:195]
    ds_read_b32 v157, v165 offset:8
    ds_read_b32 v159, v165 offset:72
    v_mfma_f32_16x16x32_bf16 v[212:215], a[24:27], v[32:35], v[212:215]
    s_waitcnt lgkmcnt(9)
    v_mfma_f32_16x16x32_bf16 v[72:75], v[176:179], v[104:107], 0
    v_cvt_pk_bf16_f32 v98, v56, v57
    v_cvt_pk_bf16_f32 v99, v58, v59
    v_mfma_f32_16x16x32_bf16 v[76:79], v[92:95], v[108:111], 0
    v_cvt_pk_bf16_f32 v100, v60, v61
    v_cvt_pk_bf16_f32 v101, v62, v63
    v_mfma_f32_16x16x32_bf16 v[232:235], v[32:35], a[28:31], v[232:235]
    buffer_load_dwordx4 a[128:131], v1, s[12:15], s70 offen offset:1024 sc1
    v_mfma_f32_16x16x32_bf16 v[252:255], a[32:35], v[32:35], v[252:255]
    ds_read_b128 v[32:35], v15 offset:21504
    buffer_load_dwordx4 v[40:43], v44, s[12:15], 0 offen sc1
    s_waitcnt vmcnt(19) lgkmcnt(7)
    v_mfma_f32_16x16x32_bf16 v[196:199], a[40:43], v[16:19], v[196:199]
    ds_write_b128 v8, v[98:101] offset:2048
    v_mfma_f32_16x16x32_bf16 v[216:219], v[16:19], a[44:47], v[216:219]
    ds_read_b32 v161, v165 offset:136
    ds_read_b32 v163, v165 offset:200
    v_mfma_f32_16x16x32_bf16 v[236:239], a[48:51], v[16:19], v[236:239]
    ds_read_b128 v[16:19], v85 offset:4096
    s_waitcnt lgkmcnt(9)
    v_mfma_f32_16x16x32_bf16 v[180:183], a[36:39], v[20:23], v[180:183]
    buffer_load_dwordx4 a[132:135], v1, s[12:15], s70 offen offset:2048 sc1
    v_mfma_f32_16x16x32_bf16 v[200:203], a[40:43], v[20:23], v[200:203]
    v_mfma_f32_16x16x32_bf16 v[220:223], v[20:23], a[44:47], v[220:223]
    v_mfma_f32_16x16x32_bf16 v[56:59], v[176:179], v[112:115], 0
    v_cvt_pk_bf16_f32 v106, v72, v73
    v_cvt_pk_bf16_f32 v107, v74, v75
    v_mfma_f32_16x16x32_bf16 v[60:63], v[92:95], v[116:119], 0
    v_cvt_pk_bf16_f32 v108, v76, v77
    v_cvt_pk_bf16_f32 v109, v78, v79
    v_mfma_f32_16x16x32_bf16 v[240:243], a[48:51], v[20:23], v[240:243]
    ds_read_b128 v[20:23], v85 offset:24576
    s_waitcnt lgkmcnt(9)
    v_mfma_f32_16x16x32_bf16 v[184:187], a[36:39], v[24:27], v[184:187]
    buffer_load_dwordx4 a[80:83], v2, s[12:15], s70 offen offset:3072 sc1
    v_mfma_f32_16x16x32_bf16 v[204:207], a[40:43], v[24:27], v[204:207]
    ds_write_b128 v8, v[106:109] offset:22528
    v_mfma_f32_16x16x32_bf16 v[224:227], v[24:27], a[44:47], v[224:227]
    v_mul_f32 v172, 0x3ea52b5c, v172
    v_mul_f32 v173, 0x3ea52b5c, v173
    v_mfma_f32_16x16x32_bf16 v[244:247], a[48:51], v[24:27], v[244:247]
    ds_read_b128 v[24:27], v85 offset:45056
    s_waitcnt lgkmcnt(10)
    v_mfma_f32_16x16x32_bf16 v[188:191], a[36:39], v[28:31], v[188:191]
    s_add_u32 s70, s70, 19200
    buffer_load_dwordx4 a[84:87], v1, s[12:15], s70 offen offset:0 sc1
    v_mfma_f32_16x16x32_bf16 v[208:211], a[40:43], v[28:31], v[208:211]
    v_mul_f32 v174, 0x3ea52b5c, v174
    v_mul_f32 v175, 0x3ea52b5c, v175
    v_mfma_f32_16x16x32_bf16 v[228:231], v[28:31], a[44:47], v[228:231]
    v_mfma_f32_16x16x32_bf16 v[72:75], v[176:179], v[120:123], 0
    v_cvt_pk_bf16_f32 v114, v56, v57
    v_cvt_pk_bf16_f32 v115, v58, v59
    v_mfma_f32_16x16x32_bf16 v[76:79], v[92:95], v[124:127], 0
    v_cvt_pk_bf16_f32 v116, v60, v61
    v_cvt_pk_bf16_f32 v117, v62, v63
    v_mfma_f32_16x16x32_bf16 v[248:251], a[48:51], v[28:31], v[248:251]
    ds_read_b128 v[28:31], v14 offset:4096
    s_waitcnt lgkmcnt(8)
    v_mfma_f32_16x16x32_bf16 v[192:195], a[36:39], v[32:35], v[192:195]
    buffer_load_dwordx4 a[136:139], v1, s[12:15], s70 offen offset:1024 sc1
    v_mfma_f32_16x16x32_bf16 v[212:215], a[40:43], v[32:35], v[212:215]
    buffer_load_dwordx4 a[140:143], v1, s[12:15], s70 offen offset:2048 sc1
    v_mfma_f32_16x16x32_bf16 v[232:235], v[32:35], a[44:47], v[232:235]
    ds_write_b128 v8, v[114:117] offset:43008
    v_mfma_f32_16x16x32_bf16 v[252:255], a[48:51], v[32:35], v[252:255]
    ds_read_b128 v[32:35], v14 offset:24576
    s_waitcnt vmcnt(20) lgkmcnt(6)
    v_mfma_f32_16x16x32_bf16 v[196:199], a[56:59], v[16:19], v[196:199]
    v_mul_f32 v164, v172, v156
    v_mul_f32 v165, v172, v157
    v_mfma_f32_16x16x32_bf16 v[216:219], v[16:19], a[60:63], v[216:219]
    s_lshl_b32 m0, s52, 10
    s_add_u32 m0, m0, 102400
    s_nop 0
    buffer_load_dwordx4 v71, s[20:23], s44 offen nt lds
    v_mfma_f32_16x16x32_bf16 v[236:239], a[88:91], v[16:19], v[236:239]
    ds_read_b128 v[16:19], v12 offset:6144
    s_waitcnt lgkmcnt(6)
    v_mfma_f32_16x16x32_bf16 v[180:183], a[52:55], v[20:23], v[180:183]
    v_mul_f32 v166, v173, v158
    v_mul_f32 v167, v173, v159
    v_mfma_f32_16x16x32_bf16 v[200:203], a[56:59], v[20:23], v[200:203]
    v_mfma_f32_16x16x32_bf16 v[56:59], v[176:179], v[128:131], 0
    v_cvt_pk_bf16_f32 v122, v72, v73
    v_cvt_pk_bf16_f32 v123, v74, v75
    v_mfma_f32_16x16x32_bf16 v[60:63], v[92:95], v[132:135], 0
    v_cvt_pk_bf16_f32 v124, v76, v77
    v_cvt_pk_bf16_f32 v125, v78, v79
    v_mfma_f32_16x16x32_bf16 v[220:223], v[20:23], a[60:63], v[220:223]
    s_lshl_b32 m0, s52, 10
    s_add_u32 m0, m0, 106496
    s_add_u32 s44, s44, 245760
    buffer_load_dwordx4 v71, s[20:23], s44 offen nt lds
    v_mfma_f32_16x16x32_bf16 v[240:243], a[88:91], v[20:23], v[240:243]
    ds_read_b128 v[20:23], v12 offset:26624
    s_waitcnt lgkmcnt(5)
    v_mfma_f32_16x16x32_bf16 v[184:187], a[52:55], v[24:27], v[184:187]
    s_lshl_b32 m0, s52, 10
    s_add_u32 m0, m0, 110592
    s_add_u32 s44, s44, 245760
    buffer_load_dwordx4 v71, s[20:23], s44 offen nt lds
    v_mfma_f32_16x16x32_bf16 v[204:207], a[56:59], v[24:27], v[204:207]
    ds_write_b128 v8, v[122:125] offset:63488
    v_mfma_f32_16x16x32_bf16 v[224:227], v[24:27], a[60:63], v[224:227]
    v_mul_f32 v168, v174, v160
    v_mul_f32 v169, v174, v161
    v_mfma_f32_16x16x32_bf16 v[244:247], a[88:91], v[24:27], v[244:247]
    ds_read_b128 v[24:27], v12 offset:47104
    s_waitcnt lgkmcnt(6)
    v_mfma_f32_16x16x32_bf16 v[188:191], a[52:55], v[28:31], v[188:191]
    v_mul_f32 v170, v175, v162
    v_mul_f32 v171, v175, v163
    v_mfma_f32_16x16x32_bf16 v[208:211], a[56:59], v[28:31], v[208:211]
    s_lshl_b32 m0, s52, 10
    s_add_u32 m0, m0, 114688
    s_add_u32 s44, s44, 245760
    buffer_load_dwordx4 v71, s[20:23], s44 offen nt lds
    v_mfma_f32_16x16x32_bf16 v[228:231], v[28:31], a[60:63], v[228:231]
    v_mfma_f32_16x16x32_bf16 v[248:251], a[88:91], v[28:31], v[248:251]
    ds_read_b128 v[28:31], v15 offset:6144
    s_waitcnt lgkmcnt(5)
    v_mfma_f32_16x16x32_bf16 v[192:195], a[52:55], v[32:35], v[192:195]
    v_cvt_pk_bf16_f32 v130, v56, v57
    v_cvt_pk_bf16_f32 v131, v58, v59
    v_mfma_f32_16x16x32_bf16 v[212:215], a[56:59], v[32:35], v[212:215]
    v_mfma_f32_16x16x32_bf16 v[232:235], v[32:35], a[60:63], v[232:235]
    v_cvt_pk_bf16_f32 v132, v60, v61
    v_cvt_pk_bf16_f32 v133, v62, v63
    v_mfma_f32_16x16x32_bf16 v[252:255], a[88:91], v[32:35], v[252:255]
    ds_read_b128 v[32:35], v15 offset:26624
    s_waitcnt vmcnt(20) lgkmcnt(5)
    v_mfma_f32_16x16x32_bf16 v[196:199], a[96:99], v[16:19], v[196:199]
    ds_write_b128 v10, v[130:133] offset:2048
    v_mfma_f32_16x16x32_bf16 v[216:219], v[16:19], a[100:103], v[216:219]
    s_waitcnt vmcnt(9)
    v_xor_b32 v40, s63, v40
    v_xor_b32 v41, s63, v41
    v_mfma_f32_16x16x32_bf16 v[236:239], a[64:67], v[16:19], v[236:239]
    ds_read_b128 v[16:19], v85 offset:9216
    s_waitcnt lgkmcnt(6)
    v_mfma_f32_16x16x32_bf16 v[180:183], a[92:95], v[20:23], v[180:183]
    s_lshl_b32 m0, s52, 10
    s_add_u32 m0, m0, 118784
    s_add_u32 s44, s44, 245760
    buffer_load_dwordx4 v71, s[20:23], s44 offen nt lds
    v_mfma_f32_16x16x32_bf16 v[200:203], a[96:99], v[20:23], v[200:203]
    v_xor_b32 v42, s63, v42
    v_xor_b32 v43, s63, v43
    v_mfma_f32_16x16x32_bf16 v[220:223], v[20:23], a[100:103], v[220:223]
    buffer_load_dwordx4 a[144:147], v2, s[12:15], s70 offen offset:3072 sc1
    v_mfma_f32_16x16x32_bf16 v[240:243], a[64:67], v[20:23], v[240:243]
    ds_read_b128 v[20:23], v85 offset:29696
    s_waitcnt lgkmcnt(5)
    v_mfma_f32_16x16x32_bf16 v[184:187], a[92:95], v[24:27], v[184:187]
    v_or_b32 v40, v40, v41
    v_or3_b32 v40, v40, v42, v43
    v_mfma_f32_16x16x32_bf16 v[204:207], a[96:99], v[24:27], v[204:207]
    v_cmp_ne_u32 s[72:73], 0, v40
    v_cmp_lt_u32 s[74:75], 7, v40
    v_mfma_f32_16x16x32_bf16 v[224:227], v[24:27], a[100:103], v[224:227]
    s_add_u32 s70, s70, 19200
    buffer_load_dwordx4 a[148:151], v1, s[12:15], s70 offen offset:0 sc1
    v_mfma_f32_16x16x32_bf16 v[244:247], a[64:67], v[24:27], v[244:247]
    ds_read_b128 v[24:27], v85 offset:50176
    s_waitcnt lgkmcnt(5)
    v_mfma_f32_16x16x32_bf16 v[188:191], a[92:95], v[28:31], v[188:191]
    s_cmp_lg_u64 s[74:75], 0
    s_cbranch_scc1 L_retry_23
L_back_24:
    s_barrier
    s_cmp_eq_u32 s73, 0
    s_cselect_b32 s59, 1, 0
    s_getpc_b64 s[4:5]
L_pc2:
    v_mfma_f32_16x16x32_bf16 v[208:211], a[96:99], v[28:31], v[208:211]
    buffer_load_dwordx4 a[152:155], v1, s[12:15], s70 offen offset:1024 sc1
    v_mfma_f32_16x16x32_bf16 v[228:231], v[28:31], a[100:103], v[228:231]
    s_sub_u32 s4, s4, L_pc2-L_begin
    s_subb_u32 s5, s5, 0
    s_mov_b32 s6, L_last-L_begin
    v_mfma_f32_16x16x32_bf16 v[248:251], a[64:67], v[28:31], v[248:251]
    ds_read_b128 v[28:31], v14 offset:9216
    s_waitcnt lgkmcnt(5)
    v_mfma_f32_16x16x32_bf16 v[192:195], a[92:95], v[32:35], v[192:195]
    buffer_load_dwordx4 a[156:159], v1, s[12:15], s70 offen offset:2048 sc1
    v_mfma_f32_16x16x32_bf16 v[212:215], a[96:99], v[32:35], v[212:215]
    s_mov_b32 s7, 0x20000
    s_lshr_b32 s3, s2, 3
    s_lshl_b32 s3, s3, 7
    v_mfma_f32_16x16x32_bf16 v[232:235], v[32:35], a[100:103], v[232:235]
    s_add_u32 s3, s3, 16384
    v_min_u32 v69, 5, v0
    v_mfma_f32_16x16x32_bf16 v[252:255], a[64:67], v[32:35], v[252:255]
    ds_read_b128 v[32:35], v14 offset:29696
    s_waitcnt lgkmcnt(5)
    s_barrier
    s_waitcnt lgkmcnt(4)
    v_mfma_f32_16x16x32_bf16 v[196:199], a[104:107], v[16:19], v[196:199]
    buffer_load_dwordx4 a[160:163], v2, s[12:15], s70 offen offset:3072 sc1
    v_mfma_f32_16x16x32_bf16 v[216:219], v[16:19], a[108:111], v[216:219]
    v_lshlrev_b32 v69, 12, v69
    v_add_u32 v69, s3, v69
    v_mfma_f32_16x16x32_bf16 v[236:239], a[112:115], v[16:19], v[236:239]
    ds_read_b128 v[16:19], v85 offset:2048
    s_waitcnt lgkmcnt(4)
    v_mfma_f32_16x16x32_bf16 v[180:183], a[68:71], v[20:23], v[180:183]
    buffer_load_dword v69, v69, s[4:7], 0 offen
    v_mfma_f32_16x16x32_bf16 v[200:203], a[104:107], v[20:23], v[200:203]
    v_mfma_f32_16x16x32_bf16 v[220:223], v[20:23], a[108:111], v[220:223]
    v_mfma_f32_16x16x32_bf16 v[240:243], a[112:115], v[20:23], v[240:243]
    ds_read_b128 v[20:23], v85 offset:22528
    s_waitcnt lgkmcnt(4)
    v_mfma_f32_16x16x32_bf16 v[184:187], a[68:71], v[24:27], v[184:187]
    v_mfma_f32_16x16x32_bf16 v[204:207], a[104:107], v[24:27], v[204:207]
    v_mfma_f32_16x16x32_bf16 v[224:227], v[24:27], a[108:111], v[224:227]
    v_mfma_f32_16x16x32_bf16 v[244:247], a[112:115], v[24:27], v[244:247]
    ds_read_b128 v[24:27], v85 offset:43008
    s_waitcnt lgkmcnt(4)
    v_mfma_f32_16x16x32_bf16 v[188:191], a[68:71], v[28:31], v[188:191]
    v_mfma_f32_16x16x32_bf16 v[208:211], a[104:107], v[28:31], v[208:211]
    v_mfma_f32_16x16x32_bf16 v[228:231], v[28:31], a[108:111], v[228:231]
    v_mfma_f32_16x16x32_bf16 v[248:251], a[112:115], v[28:31], v[248:251]
    ds_read_b128 v[28:31], v14 offset:2048
    s_waitcnt lgkmcnt(4)
    v_mfma_f32_16x16x32_bf16 v[192:195], a[68:71], v[32:35], v[192:195]
    v_mfma_f32_16x16x32_bf16 v[212:215], a[104:107], v[32:35], v[212:215]
    v_mfma_f32_16x16x32_bf16 v[232:235], v[32:35], a[108:111], v[232:235]
    v_mfma_f32_16x16x32_bf16 v[252:255], a[112:115], v[32:35], v[252:255]
    ds_read_b128 v[32:35], v14 offset:22528
    s_waitcnt lgkmcnt(4)
    v_mfma_f32_16x16x32_bf16 v[196:199], a[72:75], v[16:19], v[196:199]
    v_mfma_f32_16x16x32_bf16 v[216:219], v[16:19], a[76:79], v[216:219]
    v_mfma_f32_16x16x32_bf16 v[236:239], a[120:123], v[16:19], v[236:239]
    ds_read_b128 v[16:19], v12 offset:4096
    s_waitcnt lgkmcnt(4)
    v_mfma_f32_16x16x32_bf16 v[180:183], a[116:119], v[20:23], v[180:183]
    v_mfma_f32_16x16x32_bf16 v[200:203], a[72:75], v[20:23], v[200:203]
    v_mfma_f32_16x16x32_bf16 v[220:223], v[20:23], a[76:79], v[220:223]
    v_mfma_f32_16x16x32_bf16 v[240:243], a[120:123], v[20:23], v[240:243]
    ds_read_b128 v[20:23], v12 offset:24576
    s_waitcnt lgkmcnt(4)
    v_mfma_f32_16x16x32_bf16 v[184:187], a[116:119], v[24:27], v[184:187]
    s_add_u32 m0, s57, 122880
    s_nop 0
    buffer_load_dwordx4 v1, s[12:15], s67 offen sc1 lds
    v_mfma_f32_16x16x32_bf16 v[204:207], a[72:75], v[24:27], v[204:207]
    v_mfma_f32_16x16x32_bf16 v[224:227], v[24:27], a[76:79], v[224:227]
    v_mfma_f32_16x16x32_bf16 v[244:247], a[120:123], v[24:27], v[244:247]
    ds_read_b128 v[24:27], v12 offset:45056
    s_waitcnt lgkmcnt(4)
    v_mfma_f32_16x16x32_bf16 v[188:191], a[116:119], v[28:31], v[188:191]
    buffer_load_dwordx4 v1, s[12:15], s67 offen offset:1024 sc1 lds
    v_mfma_f32_16x16x32_bf16 v[208:211], a[72:75], v[28:31], v[208:211]
    v_mfma_f32_16x16x32_bf16 v[228:231], v[28:31], a[76:79], v[228:231]
    v_mfma_f32_16x16x32_bf16 v[248:251], a[120:123], v[28:31], v[248:251]
    ds_read_b128 v[28:31], v15 offset:4096
    s_waitcnt lgkmcnt(4)
    v_mfma_f32_16x16x32_bf16 v[192:195], a[116:119], v[32:35], v[192:195]
    buffer_load_dwordx4 v1, s[12:15], s67 offen offset:2048 sc1 lds
    v_mfma_f32_16x16x32_bf16 v[212:215], a[72:75], v[32:35], v[212:215]
    v_mfma_f32_16x16x32_bf16 v[232:235], v[32:35], a[76:79], v[232:235]
    v_mfma_f32_16x16x32_bf16 v[252:255], a[120:123], v[32:35], v[252:255]
    ds_read_b128 v[32:35], v15 offset:24576
    s_waitcnt vmcnt(9)
    s_barrier
    s_waitcnt lgkmcnt(4)
    v_mfma_f32_16x16x32_bf16 v[196:199], a[128:131], v[16:19], v[196:199]
    buffer_load_dwordx4 v1, s[12:15], s67 offen offset:3072 sc1 lds
    v_mfma_f32_16x16x32_bf16 v[216:219], v[16:19], a[132:135], v[216:219]
    ds_read_b64_tr_b16 a[164:165], v67 offset:0
    ds_read_b64_tr_b16 a[166:167], v67 offset:2048
    v_mfma_f32_16x16x32_bf16 v[236:239], a[80:83], v[16:19], v[236:239]
    ds_read_b128 v[16:19], v85 offset:7168
    s_waitcnt lgkmcnt(6)
    v_mfma_f32_16x16x32_bf16 v[180:183], a[124:127], v[20:23], v[180:183]
    s_add_u32 s67, s67, 4096
    s_add_u32 m0, s57, 126976
    s_nop 0
    buffer_load_dwordx4 v1, s[12:15], s67 offen sc1 lds
    v_mfma_f32_16x16x32_bf16 v[200:203], a[128:131], v[20:23], v[200:203]
    ds_read2_b64 a[184:187], v68 offset0:0 offset1:4
    ds_read_b64_tr_b16 a[168:169], v67 offset:4096
    v_mfma_f32_16x16x32_bf16 v[220:223], v[20:23], a[132:135], v[220:223]
    ds_read_b64_tr_b16 a[170:171], v67 offset:6144
    ds_read2_b64 a[188:191], v68 offset0:8 offset1:12
    v_mfma_f32_16x16x32_bf16 v[240:243], a[80:83], v[20:23], v[240:243]
    ds_read_b128 v[20:23], v85 offset:27648
    s_waitcnt lgkmcnt(10)
    v_mfma_f32_16x16x32_bf16 v[184:187], a[124:127], v[24:27], v[184:187]
    buffer_load_dwordx4 a[204:207], v1, s[12:15], s64 offen sc1
    v_mfma_f32_16x16x32_bf16 v[204:207], a[128:131], v[24:27], v[204:207]
    ds_read_b64_tr_b16 a[172:173], v67 offset:8192
    ds_read_b64_tr_b16 a[174:175], v67 offset:10240
    v_mfma_f32_16x16x32_bf16 v[224:227], v[24:27], a[132:135], v[224:227]
    ds_read2_b64 a[192:195], v68 offset0:16 offset1:20
    ds_read_b64_tr_b16 a[176:177], v67 offset:12288
    v_mfma_f32_16x16x32_bf16 v[244:247], a[80:83], v[24:27], v[244:247]
    ds_read_b128 v[24:27], v85 offset:48128
    s_waitcnt lgkmcnt(14)
    v_mfma_f32_16x16x32_bf16 v[188:191], a[124:127], v[28:31], v[188:191]
    buffer_load_dwordx4 a[208:211], v5, s[12:15], s64 offen sc1
    v_mfma_f32_16x16x32_bf16 v[208:211], a[128:131], v[28:31], v[208:211]
    ds_read_b64_tr_b16 a[178:179], v67 offset:14336
    ds_read2_b64 a[196:199], v68 offset0:24 offset1:28
    v_mfma_f32_16x16x32_bf16 v[228:231], v[28:31], a[132:135], v[228:231]
    ds_read_b64_tr_b16 a[180:181], v67 offset:16384
    ds_read_b64_tr_b16 a[182:183], v67 offset:18432
    v_mfma_f32_16x16x32_bf16 v[248:251], a[80:83], v[28:31], v[248:251]
    ds_read_b128 v[28:31], v14 offset:7168
    s_waitcnt lgkmcnt(15)
    v_mfma_f32_16x16x32_bf16 v[192:195], a[124:127], v[32:35], v[192:195]
    ds_read2_b64 a[200:203], v68 offset0:32 offset1:36
    v_mov_b32 v60, 0xff
    v_mfma_f32_16x16x32_bf16 v[212:215], a[128:131], v[32:35], v[212:215]
    v_mfma_f32_16x16x32_bf16 v[232:235], v[32:35], a[132:135], v[232:235]
    buffer_load_dwordx4 a[212:215], v6, s[12:15], s64 offen sc1
    v_mfma_f32_16x16x32_bf16 v[252:255], a[80:83], v[32:35], v[252:255]
    ds_read_b128 v[32:35], v14 offset:27648
    s_waitcnt vmcnt(13)
    v_mfma_f32_16x16x32_bf16 v[196:199], a[136:139], v[16:19], v[196:199]
    s_waitcnt lgkmcnt(15)
    v_mfma_f32_16x16x32_bf16 v[56:59], a[164:167], a[184:187], 0
    s_waitcnt lgkmcnt(13)
    v_mfma_f32_16x16x32_bf16 v[56:59], a[168:171], a[188:191], v[56:59]
    s_waitcnt lgkmcnt(9)
    v_mfma_f32_16x16x32_bf16 v[56:59], a[172:175], a[192:195], v[56:59]
    s_waitcnt lgkmcnt(5)
    v_mfma_f32_16x16x32_bf16 v[56:59], a[176:179], a[196:199], v[56:59]
    s_waitcnt lgkmcnt(1)
    v_mfma_f32_16x16x32_bf16 v[56:59], a[180:183], a[200:203], v[56:59]
    v_mfma_f32_16x16x32_bf16 v[216:219], v[16:19], a[140:143], v[216:219]
    buffer_load_dwordx4 a[216:219], v1, s[12:15], s64 offen offset:1024 sc1
    v_mfma_f32_16x16x32_bf16 v[236:239], a[144:147], v[16:19], v[236:239]
    ds_read_b128 v[16:19], v12 offset:9216
    v_mfma_f32_16x16x32_bf16 v[180:183], a[84:87], v[20:23], v[180:183]
    v_mfma_f32_16x16x32_bf16 v[200:203], a[136:139], v[20:23], v[200:203]
    v_mfma_f32_16x16x32_bf16 v[220:223], v[20:23], a[140:143], v[220:223]
    v_mfma_f32_16x16x32_bf16 v[240:243], a[144:147], v[20:23], v[240:243]
    ds_read_b128 v[20:23], v12 offset:29696
    v_mfma_f32_16x16x32_bf16 v[184:187], a[84:87], v[24:27], v[184:187]
    v_add_u32 v56, 0x80, v56
    v_add_u32 v57, 0x80, v57
    v_mfma_f32_16x16x32_bf16 v[204:207], a[136:139], v[24:27], v[204:207]
    v_add_u32 v58, 0x80, v58
    v_add_u32 v59, 0x80, v59
    v_mfma_f32_16x16x32_bf16 v[224:227], v[24:27], a[140:143], v[224:227]
    v_bfi_b32 v56, v60, s58, v56
    v_bfi_b32 v57, v60, s58, v57
    v_mfma_f32_16x16x32_bf16 v[244:247], a[144:147], v[24:27], v[244:247]
    ds_read_b128 v[24:27], v12 offset:50176
    v_mfma_f32_16x16x32_bf16 v[188:191], a[84:87], v[28:31], v[188:191]
    v_bfi_b32 v58, v60, s58, v58
    v_bfi_b32 v59, v60, s58, v59
    v_mfma_f32_16x16x32_bf16 v[208:211], a[136:139], v[28:31], v[208:211]
    buffer_store_dwordx4 v[56:59], v70, s[12:15], s45 offen sc1
    v_mfma_f32_16x16x32_bf16 v[228:231], v[28:31], a[140:143], v[228:231]
    v_mfma_f32_16x16x32_bf16 v[248:251], a[144:147], v[28:31], v[248:251]
    ds_read_b128 v[28:31], v15 offset:9216
    s_waitcnt lgkmcnt(4)
    v_mfma_f32_16x16x32_bf16 v[192:195], a[84:87], v[32:35], v[192:195]
    v_mfma_f32_16x16x32_bf16 v[212:215], a[136:139], v[32:35], v[212:215]
    v_mfma_f32_16x16x32_bf16 v[232:235], v[32:35], a[140:143], v[232:235]
    v_mfma_f32_16x16x32_bf16 v[252:255], a[144:147], v[32:35], v[252:255]
    ds_read_b128 v[32:35], v15 offset:29696
    s_waitcnt vmcnt(11) lgkmcnt(4)
    v_mfma_f32_16x16x32_bf16 v[196:199], a[152:155], v[16:19], v[196:199]
    v_mfma_f32_16x16x32_bf16 v[216:219], v[16:19], a[156:159], v[216:219]
    buffer_load_dwordx4 a[220:223], v5, s[12:15], s64 offen offset:1024 sc1
    v_mfma_f32_16x16x32_bf16 v[236:239], a[160:163], v[16:19], v[236:239]
    s_waitcnt lgkmcnt(3)
    v_mfma_f32_16x16x32_bf16 v[180:183], a[148:151], v[20:23], v[180:183]
    v_mfma_f32_16x16x32_bf16 v[200:203], a[152:155], v[20:23], v[200:203]
    buffer_load_dwordx4 a[224:227], v6, s[12:15], s64 offen offset:1024 sc1
    v_mfma_f32_16x16x32_bf16 v[220:223], v[20:23], a[156:159], v[220:223]
    v_mfma_f32_16x16x32_bf16 v[240:243], a[160:163], v[20:23], v[240:243]
    s_waitcnt lgkmcnt(2)
    v_mfma_f32_16x16x32_bf16 v[184:187], a[148:151], v[24:27], v[184:187]
    v_mfma_f32_16x16x32_bf16 v[204:207], a[152:155], v[24:27], v[204:207]
    buffer_load_dwordx4 a[228:231], v1, s[12:15], s64 offen offset:2048 sc1
    v_mfma_f32_16x16x32_bf16 v[224:227], v[24:27], a[156:159], v[224:227]
    v_mfma_f32_16x16x32_bf16 v[244:247], a[160:163], v[24:27], v[244:247]
    s_waitcnt lgkmcnt(1)
    v_mfma_f32_16x16x32_bf16 v[188:191], a[148:151], v[28:31], v[188:191]
    v_mfma_f32_16x16x32_bf16 v[208:211], a[152:155], v[28:31], v[208:211]
    buffer_load_dwordx4 a[232:235], v5, s[12:15], s64 offen offset:2048 sc1
    v_mfma_f32_16x16x32_bf16 v[228:231], v[28:31], a[156:159], v[228:231]
    v_mfma_f32_16x16x32_bf16 v[248:251], a[160:163], v[28:31], v[248:251]
    s_waitcnt lgkmcnt(0)
    v_mfma_f32_16x16x32_bf16 v[192:195], a[148:151], v[32:35], v[192:195]
    v_mfma_f32_16x16x32_bf16 v[212:215], a[152:155], v[32:35], v[212:215]
    buffer_load_dwordx4 a[236:239], v6, s[12:15], s64 offen offset:2048 sc1
    v_mfma_f32_16x16x32_bf16 v[232:235], v[32:35], a[156:159], v[232:235]
    v_mfma_f32_16x16x32_bf16 v[252:255], a[160:163], v[32:35], v[252:255]
    s_barrier
    v_cvt_pk_bf16_f32 v126, v236, v237
    v_cvt_pk_bf16_f32 v127, v238, v239
    v_cvt_pk_bf16_f32 v66, v240, v241
    v_cvt_pk_bf16_f32 v67, v242, v243
    v_cvt_pk_bf16_f32 v70, v244, v245
    v_cvt_pk_bf16_f32 v71, v246, v247
    v_cvt_pk_bf16_f32 v74, v248, v249
    v_cvt_pk_bf16_f32 v75, v250, v251
    v_cvt_pk_bf16_f32 v78, v252, v253
    v_cvt_pk_bf16_f32 v79, v254, v255
    ds_write_b64 v37, v[126:127] offset:0
    v_cvt_pk_bf16_f32 v80, v196, v197
    v_cvt_pk_bf16_f32 v81, v198, v199
    ds_write_b64 v37, v[66:67] offset:512
    v_cvt_pk_bf16_f32 v84, v200, v201
    v_cvt_pk_bf16_f32 v85, v202, v203
    ds_write_b64 v37, v[70:71] offset:1024
    v_cvt_pk_bf16_f32 v88, v204, v205
    v_cvt_pk_bf16_f32 v89, v206, v207
    s_add_u32 m0, s61, 40960
    s_nop 0
    buffer_load_dwordx4 v1, s[12:15], s62 offen sc1 lds
    ds_write_b64 v37, v[74:75] offset:1536
    v_cvt_pk_bf16_f32 v92, v208, v209
    v_cvt_pk_bf16_f32 v93, v210, v211
    ds_write_b64 v37, v[78:79] offset:2048
    v_cvt_pk_bf16_f32 v96, v212, v213
    v_cvt_pk_bf16_f32 v97, v214, v215
    ds_read_b64 v[82:83], v36 offset:128
    ds_read_b64 v[86:87], v36 offset:640
    ds_read_b64 v[90:91], v36 offset:1152
    ds_read_b64 v[94:95], v36 offset:1664
    ds_read_b64 v[98:99], v36 offset:2176
    buffer_load_dwordx4 v1, s[12:15], s62 offen offset:1024 sc1 lds
    v_cvt_pk_bf16_f32 v64, v180, v181
    v_cvt_pk_bf16_f32 v65, v182, v183
    v_cvt_pk_bf16_f32 v68, v184, v185
    s_waitcnt vmcnt(17)
    v_cvt_pk_bf16_f32 v69, v186, v187
    v_cvt_pk_bf16_f32 v72, v188, v189
    v_cvt_pk_bf16_f32 v73, v190, v191
    v_cvt_pk_bf16_f32 v76, v192, v193
    v_cvt_pk_bf16_f32 v77, v194, v195
    s_waitcnt lgkmcnt(4)
    v_mfma_f32_16x16x32_bf16 v[180:183], v[80:83], v[64:67], v[148:151]
    buffer_load_dwordx4 v1, s[12:15], s62 offen offset:2048 sc1 lds
    ds_read_b64_tr_b16 v[110:111], v152 offset:256
    ds_read_b64_tr_b16 v[112:113], v152 offset:768
    s_waitcnt lgkmcnt(5)
    v_mfma_f32_16x16x32_bf16 v[184:187], v[84:87], v[64:67], v[140:143]
    ds_read_b64_tr_b16 v[114:115], v153 offset:768
    ds_read_b64_tr_b16 v[116:117], v153 offset:1280
    v_mfma_f32_16x16x32_bf16 v[188:191], v[84:87], v[68:71], v[136:139]
    ds_read_b64_tr_b16 v[118:119], v154 offset:1280
    ds_read_b64_tr_b16 v[120:121], v154 offset:1792
    s_waitcnt lgkmcnt(8)
    v_mfma_f32_16x16x32_bf16 v[192:195], v[88:91], v[68:71], v[140:143]
    ds_read_b64_tr_b16 v[122:123], v155 offset:1792
    ds_read_b64_tr_b16 v[124:125], v155 offset:2304
    buffer_load_dwordx4 v1, s[12:15], s62 offen offset:3072 sc1 lds
    v_mfma_f32_16x16x32_bf16 v[196:199], v[88:91], v[72:75], v[136:139]
    v_cvt_pk_bf16_f32 v100, v216, v217
    v_cvt_pk_bf16_f32 v101, v218, v219
    s_waitcnt lgkmcnt(9)
    v_mfma_f32_16x16x32_bf16 v[200:203], v[92:95], v[72:75], v[140:143]
    v_cvt_pk_bf16_f32 v102, v220, v221
    v_cvt_pk_bf16_f32 v103, v222, v223
    v_mfma_f32_16x16x32_bf16 v[204:207], v[92:95], v[76:79], v[136:139]
    v_max3_f32 v16, v180, v181, v184
    v_max3_f32 v17, v182, v183, v186
    s_waitcnt lgkmcnt(8)
    v_mfma_f32_16x16x32_bf16 v[208:211], v[96:99], v[76:79], v[140:143]
    v_max_f32 v16, v16, v185
    s_add_u32 s62, s62, 4096
    s_add_u32 m0, s61, 45056
    s_nop 0
    buffer_load_dwordx4 v1, s[12:15], s62 offen sc1 lds
    v_max_f32 v17, v17, v187
    v_max3_f32 v18, v188, v189, v192
    v_max3_f32 v19, v190, v191, v194
    v_max_f32 v18, v18, v193
    v_max_f32 v19, v19, v195
    v_max3_f32 v20, v196, v197, v200
    v_max3_f32 v21, v198, v199, v202
    v_max_f32 v20, v20, v201
    v_max_f32 v21, v21, v203
    v_max3_f32 v22, v204, v205, v208
    v_max3_f32 v23, v206, v207, v210
    buffer_load_dwordx4 v1, s[12:15], s62 offen offset:1024 sc1 lds
    v_max_f32 v22, v22, v209
    v_max_f32 v23, v23, v211
    v_pk_mul_f32 v[16:17], v[16:17], v[164:165]
    v_pk_mul_f32 v[18:19], v[18:19], v[166:167]
    v_pk_mul_f32 v[20:21], v[20:21], v[168:169]
    v_pk_mul_f32 v[22:23], v[22:23], v[170:171]
    v_max_f32 v24, v16, v17
    v_max_f32 v26, v18, v19
    v_max_f32 v28, v20, v21
    v_max_f32 v30, v22, v23
    v_cvt_pk_bf16_f32 v104, v224, v225
    v_cvt_pk_bf16_f32 v105, v226, v227
    v_permlane32_swap_b32 v24, v28
    v_permlane32_swap_b32 v26, v30
    buffer_load_dwordx4 v1, s[12:15], s62 offen offset:2048 sc1 lds
    v_max_f32 v24, v24, v28
    v_max_f32 v26, v26, v30
    v_cvt_pk_bf16_f32 v106, v228, v229
    v_cvt_pk_bf16_f32 v107, v230, v231
    v_permlane16_swap_b32 v24, v26
    v_max_f32 v24, v24, v26
    v_mov_b32 v26, v24
    v_cvt_pk_bf16_f32 v108, v232, v233
    v_cvt_pk_bf16_f32 v109, v234, v235
    v_permlane16_swap_b32 v24, v26
    v_mov_b32 v28, v24
    v_mov_b32 v30, v26
    s_nop 0
    v_permlane32_swap_b32 v24, v28
    buffer_load_dwordx4 v1, s[12:15], s62 offen offset:3072 sc1 lds
    v_permlane32_swap_b32 v26, v30
    v_pk_add_f32 v[16:17], v[16:17], v[24:25] op_sel_hi:[1,0] neg_lo:[0,1] neg_hi:[0,1]
    v_pk_add_f32 v[18:19], v[18:19], v[26:27] op_sel_hi:[1,0] neg_lo:[0,1] neg_hi:[0,1]
    v_pk_add_f32 v[20:21], v[20:21], v[28:29] op_sel_hi:[1,0] neg_lo:[0,1] neg_hi:[0,1]
    v_pk_add_f32 v[22:23], v[22:23], v[30:31] op_sel_hi:[1,0] neg_lo:[0,1] neg_hi:[0,1]
    v_exp_f32 v16, v16
    v_exp_f32 v17, v17
    v_exp_f32 v18, v18
    v_exp_f32 v19, v19
    v_exp_f32 v20, v20
    s_add_u32 s62, s62, 4096
    s_add_u32 m0, s61, 49152
    s_nop 0
    buffer_load_dwordx4 v1, s[12:15], s62 offen sc1 lds
    v_exp_f32 v21, v21
    v_exp_f32 v22, v22
    v_exp_f32 v23, v23
    v_add_f32 v24, v16, v17
    v_add_f32 v26, v18, v19
    v_add_f32 v28, v20, v21
    v_add_f32 v30, v22, v23
    buffer_load_dwordx4 v1, s[12:15], s62 offen offset:1024 sc1 lds
    v_mul_f32 v16, v16, v156
    v_mul_f32 v17, v17, v157
    v_permlane32_swap_b32 v24, v28
    v_permlane32_swap_b32 v26, v30
    v_add_f32 v24, v24, v28
    v_add_f32 v26, v26, v30
    v_mul_f32 v18, v18, v158
    v_mul_f32 v19, v19, v159
    v_permlane16_swap_b32 v24, v26
    v_add_f32 v24, v24, v26
    v_rcp_f32 v24, v24
    buffer_load_dwordx4 v1, s[12:15], s62 offen offset:2048 sc1 lds
    v_mul_f32 v20, v20, v160
    v_mov_b32 v26, v24
    v_mul_f32 v21, v21, v161
    v_mul_f32 v22, v22, v162
    v_permlane16_swap_b32 v24, v26
    v_mov_b32 v28, v24
    v_mov_b32 v30, v26
    v_mul_f32 v23, v23, v163
    v_permlane32_swap_b32 v24, v28
    v_permlane32_swap_b32 v26, v30
    buffer_load_dwordx4 v1, s[12:15], s62 offen offset:3072 sc1 lds
    v_pk_mul_f32 v[16:17], v[16:17], v[24:25] op_sel_hi:[1,0]
    v_pk_mul_f32 v[18:19], v[18:19], v[26:27] op_sel_hi:[1,0]
    v_pk_mul_f32 v[20:21], v[20:21], v[28:29] op_sel_hi:[1,0]
    v_pk_mul_f32 v[22:23], v[22:23], v[30:31] op_sel_hi:[1,0]
    v_cvt_pk_bf16_f32 v16, v16, v17
    v_cvt_pk_bf16_f32 v18, v18, v19
    v_cvt_pk_bf16_f32 v20, v20, v21
    v_cvt_pk_bf16_f32 v22, v22, v23
    v_perm_b32 v180, v16, v16, v144
    v_perm_b32 v181, v16, v16, v145
    v_perm_b32 v182, v16, v16, v146
    v_perm_b32 v183, v16, v16, v147
    v_perm_b32 v188, v18, v18, v144
    v_perm_b32 v189, v18, v18, v145
    v_mfma_f32_16x16x32_bf16 v[212:215], v[100:103], v[180:183], 0
    v_perm_b32 v190, v18, v18, v146
    v_perm_b32 v191, v18, v18, v147
    s_waitcnt lgkmcnt(6)
    v_mfma_f32_16x16x32_bf16 v[228:231], v[110:113], v[180:183], 0
    v_perm_b32 v196, v20, v20, v144
    v_perm_b32 v197, v20, v20, v145
    v_mfma_f32_16x16x32_bf16 v[216:219], v[102:105], v[188:191], 0
    v_perm_b32 v198, v20, v20, v146
    v_perm_b32 v199, v20, v20, v147
    s_waitcnt lgkmcnt(4)
    v_mfma_f32_16x16x32_bf16 v[228:231], v[114:117], v[188:191], v[228:231]
    v_perm_b32 v204, v22, v22, v144
    v_perm_b32 v205, v22, v22, v145
    v_mfma_f32_16x16x32_bf16 v[220:223], v[104:107], v[196:199], 0
    v_perm_b32 v206, v22, v22, v146
    v_perm_b32 v207, v22, v22, v147
    s_waitcnt lgkmcnt(2)
    v_mfma_f32_16x16x32_bf16 v[228:231], v[118:121], v[196:199], v[228:231]
    v_cvt_pk_bf16_f32 v24, v212, v213
    v_cvt_pk_bf16_f32 v25, v214, v215
    v_mfma_f32_16x16x32_bf16 v[224:227], v[106:109], v[204:207], 0
    s_waitcnt lgkmcnt(0)
    v_mfma_f32_16x16x32_bf16 v[228:231], v[122:125], v[204:207], v[228:231]
    v_cvt_pk_bf16_f32 v26, v216, v217
    v_cvt_pk_bf16_f32 v27, v218, v219
    v_cvt_pk_bf16_f32 v28, v220, v221
    v_cvt_pk_bf16_f32 v29, v222, v223
    v_permlane32_swap_b32 v24, v26
    v_permlane32_swap_b32 v25, v27
    buffer_store_dwordx4 v[24:27], v39, s[12:15], s28 offen sc1
    v_cvt_pk_bf16_f32 v30, v224, v225
    v_cvt_pk_bf16_f32 v31, v226, v227
    v_cvt_pk_bf16_f32 v32, v228, v229
    v_cvt_pk_bf16_f32 v33, v230, v231
    v_permlane32_swap_b32 v28, v30
    v_permlane32_swap_b32 v29, v31
    buffer_store_dwordx4 v[28:31], v39, s[12:15], s29 offen sc1
    buffer_store_dwordx2 v[32:33], v38, s[12:15], s30 offen sc1
    v_and_b32 v45, 31, v0
    v_min_u32 v45, 19, v45
    v_lshrrev_b32 v46, 5, v0
    v_mul_u32_u24 v46, 15360, v46
    v_lshl_add_u32 v45, v45, 4, v46
    s_mul_i32 s46, s52, 2560
    s_mul_i32 s47, s53, 320
    s_add_u32 s46, s46, s47
    s_add_u32 s46, s46, 22615040
    buffer_load_dwordx4 v[48:51], v45, s[12:15], s46 offen sc1
    s_add_u32 s46, s46, 30720
    buffer_load_dwordx4 v[52:55], v45, s[12:15], s46 offen sc1
    s_add_u32 s62, s62, 4096
    s_add_u32 m0, s61, 53248
    s_nop 0
    buffer_load_dwordx4 v1, s[12:15], s62 offen sc1 lds
    buffer_load_dwordx4 v1, s[12:15], s62 offen offset:1024 sc1 lds
    buffer_load_dwordx4 v1, s[12:15], s62 offen offset:2048 sc1 lds
    v_accvgpr_read_b32 v97, a244
    v_lshlrev_b32 v96, 16, v97
    v_and_b32 v97, s71, v97
    v_accvgpr_read_b32 v99, a245
    v_lshlrev_b32 v98, 16, v99
    v_and_b32 v99, s71, v99
    v_accvgpr_read_b32 v101, a246
    v_lshlrev_b32 v100, 16, v101
    v_and_b32 v101, s71, v101
    v_accvgpr_read_b32 v103, a247
    v_lshlrev_b32 v102, 16, v103
    v_and_b32 v103, s71, v103
    v_accvgpr_read_b32 v105, a248
    v_lshlrev_b32 v104, 16, v105
    v_and_b32 v105, s71, v105
    v_accvgpr_read_b32 v107, a249
    v_lshlrev_b32 v106, 16, v107
    v_and_b32 v107, s71, v107
    v_accvgpr_read_b32 v109, a250
    v_lshlrev_b32 v108, 16, v109
    v_and_b32 v109, s71, v109
    v_accvgpr_read_b32 v111, a251
    v_lshlrev_b32 v110, 16, v111
    v_and_b32 v111, s71, v111
    v_accvgpr_read_b32 v113, a252
    v_lshlrev_b32 v112, 16, v113
    v_and_b32 v113, s71, v113
    v_accvgpr_read_b32 v115, a253
    v_lshlrev_b32 v114, 16, v115
    v_and_b32 v115, s71, v115
    s_and_b32 s4, s53, 1
    s_lshl_b32 s5, s4, 6
    s_add_u32 s5, s5, 153600
    v_lshl_add_u32 v9, v4, 5, s5
    s_xor_b32 s4, s4, 1
    s_lshl_b32 s4, s4, 8
    s_add_u32 s4, s4, 153600
    v_and_b32 v10, 1, v4
    v_lshl_add_u32 v10, v10, 5, s4
    v_lshrrev_b32 v15, 1, v4
    v_lshl_add_u32 v10, v15, 4, v10
    s_lshl_b32 s28, s54, 2
    s_add_u32 s28, s28, s52
    s_lshl_b32 s30, s28, 11
    s_mul_i32 s28, s28, 20480
    s_add_u32 s29, s28, 10027008
    s_add_u32 s28, s28, 10027008
    v_and_b32 v8, 1, v0
    v_mul_u32_u24 v8, 504, v8
    v_lshl_add_u32 v11, v0, 3, v8
    v_add_u32 v8, 40960, v1
    v_add_u32 v12, 102400, v1
    buffer_load_dwordx4 v1, s[12:15], s62 offen offset:3072 sc1 lds
    s_add_u32 s62, s62, 4096
    s_add_u32 m0, s61, 57344
    s_nop 0
    buffer_load_dwordx4 v1, s[12:15], s62 offen sc1 lds
    buffer_load_dwordx4 v1, s[12:15], s62 offen offset:1024 sc1 lds
    s_lshl_b32 s4, s54, 12
    s_add_u32 s4, s4, 65536
    s_lshl_b32 s5, s53, 2
    s_add_u32 s5, s5, s4
    s_add_u32 s5, s5, 22675456
    s_lshl_b32 s6, s52, 28
    v_lshlrev_b32 v15, 26, v0
    v_and_b32 v15, 0x80000000, v15
    v_lshl_add_u32 v14, v0, 7, v15
    v_or_b32 v14, s6, v14
    v_mov_b32 v15, s58
    s_mov_b32 s6, s58
    s_mov_b32 s7, s58
    s_waitcnt vmcnt(8)
    s_barrier
    s_cmp_eq_u32 s59, 1
    s_cbranch_scc0 L_slow_27
    buffer_store_dword v15, v14, s[12:15], s5 offen
L_back_28:
    buffer_load_dwordx4 v1, s[12:15], s62 offen offset:2048 sc1 lds
    buffer_load_dwordx4 v1, s[12:15], s62 offen offset:3072 sc1 lds
    s_add_u32 m0, s60, 0
    s_nop 0
    buffer_load_dwordx4 v7, s[12:15], s66 offen sc1 lds
    buffer_load_dwordx4 a[240:243], v1, s[12:15], s65 offen sc1
    buffer_load_dwordx4 v7, s[12:15], s66 offen offset:1024 sc1 lds
    s_and_b32 s47, s58, 0xff
    s_waitcnt vmcnt(13)
    v_xor_b32 v48, s47, v48
    v_xor_b32 v49, s47, v49
    v_xor_b32 v50, s47, v50
    v_xor_b32 v51, s47, v51
    s_waitcnt vmcnt(12)
    v_xor_b32 v52, s47, v52
    v_xor_b32 v53, s47, v53
    v_xor_b32 v54, s47, v54
    v_xor_b32 v55, s47, v55
    v_or_b32 v47, v48, v49
    v_or3_b32 v47, v47, v50, v51
    v_or3_b32 v47, v47, v52, v53
    v_or3_b32 v47, v47, v54, v55
    v_and_b32 v47, 0xff, v47
    v_cmp_ne_u32 vcc, 0, v47
    s_cbranch_vccnz L_retry_29
L_back_30:
    v_permlane32_swap_b32 v48, v52
    v_permlane32_swap_b32 v49, v53
    v_permlane32_swap_b32 v50, v54
    v_permlane32_swap_b32 v51, v55
    v_pk_add_f32 v[48:49], v[48:49], v[52:53]
    v_pk_add_f32 v[50:51], v[50:51], v[54:55]
    s_cmp_eq_u32 s52, 2
    s_cselect_b32 s46, 1.0, 0
    v_permlane32_swap_b32 v48, v52
    v_permlane32_swap_b32 v49, v53
    v_permlane32_swap_b32 v50, v54
    v_permlane32_swap_b32 v51, v55
    v_pk_add_f32 v[48:49], v[48:49], v[52:53]
    v_pk_add_f32 v[50:51], v[50:51], v[54:55]
    v_cvt_pk_bf16_f32 v49, v48, v49
    v_lshlrev_b32 v48, 16, v49
    v_and_b32 v49, s71, v49
    v_cvt_pk_bf16_f32 v51, v50, v51
    v_lshlrev_b32 v50, 16, v51
    v_and_b32 v51, s71, v51
    v_add_f32 v48, s46, v48
    v_add_f32 v49, s46, v49
    v_add_f32 v50, s46, v50
    v_add_f32 v51, s46, v51
    v_cvt_pk_bf16_f32 v49, v48, v49
    v_lshlrev_b32 v48, 16, v49
    v_and_b32 v49, s71, v49
    v_cvt_pk_bf16_f32 v51, v50, v51
    v_lshlrev_b32 v50, 16, v51
    v_and_b32 v51, s71, v51
    s_mul_i32 s46, s52, 320
    s_add_u32 s46, s46, 153600
    v_add_u32 v45, s46, v1
    s_mov_b64 exec, 0xfffff
    ds_write_b128 v45, v[48:51]
    s_mov_b64 exec, -1
    s_waitcnt lgkmcnt(0)
    s_load_dwordx8 s[36:43], s[34:35], s4
    s_mov_b32 s3, 0
    s_branch L_first_34
L_retry_33:
    s_waitcnt lgkmcnt(0)
    s_add_u32 s3, s3, 1
    s_cmp_gt_u32 s3, 0x20000
    s_cbranch_scc1 L_done_35
    s_cmp_lt_u32 s3, 32
    s_cbranch_scc0 L_coherent_36
    s_add_u32 s4, s4, 128
    s_load_dwordx8 s[36:43], s[34:35], s4
L_back_37:
L_first_34:
    s_waitcnt lgkmcnt(0)
    s_cmp_lg_u64 s[36:37], s[6:7]
    s_cbranch_scc1 L_retry_33
    s_cmp_lg_u64 s[38:39], s[6:7]
    s_cbranch_scc1 L_retry_33
    s_cmp_lg_u64 s[40:41], s[6:7]
    s_cbranch_scc1 L_retry_33
    s_cmp_lg_u64 s[42:43], s[6:7]
    s_cbranch_scc1 L_retry_33
L_done_35:
    s_add_u32 s28, s28, 16384
    buffer_load_dwordx4 v[240:243], v11, s[12:15], s28 offen sc1
    buffer_load_dwordx4 v[244:247], v11, s[12:15], s28 offen offset:1024 sc1
    buffer_load_dwordx4 v[248:251], v11, s[12:15], s28 offen offset:2048 sc1
    buffer_load_dwordx4 v[252:255], v11, s[12:15], s28 offen offset:3072 sc1
    s_sub_u32 s28, s28, 16384
    buffer_load_dwordx4 v[176:179], v1, s[12:15], s28 offen sc1
    buffer_load_dwordx4 v[180:183], v1, s[12:15], s28 offen offset:1024 sc1
    buffer_load_dwordx4 v[184:187], v1, s[12:15], s28 offen offset:2048 sc1
    buffer_load_dwordx4 v[188:191], v1, s[12:15], s28 offen offset:3072 sc1
    s_add_u32 s28, s28, 4096
    buffer_load_dwordx4 v[192:195], v1, s[12:15], s28 offen sc1
    buffer_load_dwordx4 v[196:199], v1, s[12:15], s28 offen offset:1024 sc1
    s_waitcnt vmcnt(13)
    s_barrier
    ds_read_b128 v[136:139], v12 offset:20480
    ds_read_b128 v[140:143], v12 offset:21504
    ds_read_b128 v[144:147], v12 offset:22528
    ds_read_b128 v[148:151], v12 offset:23552
    ds_read_b128 v[152:155], v12 offset:24576
    ds_read_b128 v[156:159], v12 offset:25600
    ds_read_b128 v[160:163], v12 offset:26624
    ds_read_b128 v[164:167], v12 offset:27648
    ds_read_b128 v[168:171], v12 offset:28672
    ds_read_b128 v[172:175], v12 offset:29696
    ds_read_b128 v[76:79], v9 offset:0
    ds_read_b128 v[80:83], v9 offset:16
    ds_read_b128 v[84:87], v9 offset:128
    ds_read_b128 v[88:91], v9 offset:144
    ds_read_b128 v[92:95], v10 offset:0
    ds_read_b128 v[56:59], v9 offset:320
    ds_read_b128 v[60:63], v9 offset:336
    ds_read_b128 v[64:67], v9 offset:448
    ds_read_b128 v[68:71], v9 offset:464
    ds_read_b128 v[72:75], v10 offset:320
    ds_read_b128 v[36:39], v9 offset:640
    ds_read_b128 v[40:43], v9 offset:656
    ds_read_b128 v[44:47], v9 offset:768
    ds_read_b128 v[48:51], v9 offset:784
    ds_read_b128 v[52:55], v10 offset:640
    s_add_u32 s30, s30, 22347776
    s_lshr_b32 s4, s53, 1
    s_lshl_b32 s4, s4, 9
    s_add_u32 s31, s30, s4
    s_and_b32 s4, s53, 1
    s_lshl_b32 s4, s4, 3
    s_add_u32 s31, s31, s4
    v_lshrrev_b32 v32, 1, v4
    v_lshlrev_b32 v32, 8, v32
    v_lshl_add_u32 v32, v3, 4, v32
    v_and_b32 v31, 1, v4
    v_lshl_or_b32 v30, v31, 31, v32
    v_lshl_add_u32 v31, v31, 10, v32
    s_lshr_b32 s4, s53, 1
    s_mul_i32 s4, s4, 5120
    s_add_u32 s29, s29, s4
    s_and_b32 s5, s53, 1
    s_mul_i32 s4, s5, 3072
    s_add_u32 s72, s4, s29
    s_lshl_b32 s5, s5, 9
    s_add_u32 s73, s5, s29
    v_lshlrev_b32 v32, 26, v0
    v_and_b32 v32, 0x80000000, v32
    v_or_b32 v32, v32, v1
    s_lshl_b32 s4, s56, 12
    s_add_u32 s4, s4, 196608
    s_lshl_b32 s32, s52, 10
    s_add_u32 s32, s32, s4
    s_and_b32 s5, s54, 1
    s_lshl_b32 s5, s5, 11
    s_add_u32 s4, s4, s5
    s_and_b32 s5, s52, 1
    s_lshl_b32 s5, s5, 10
    s_add_u32 s4, s4, s5
    s_lshr_b32 s5, s52, 1
    s_lshl_b32 s5, s5, 3
    s_add_u32 s5, s5, s53
    s_lshl_b32 s5, s5, 2
    s_add_u32 s4, s4, s5
    s_add_u32 s33, s4, 22675456
    v_lshlrev_b32 v14, 28, v4
    v_lshl_or_b32 v14, v3, 6, v14
    v_mov_b32 v17, s58
    s_mov_b32 s4, 0x3acccccd
    s_mov_b32 vcc_lo, 0x55555555
    s_mov_b32 vcc_hi, 0x55555555
    s_waitcnt vmcnt(9)
    v_cndmask_b32_dpp v20, v242, v240, vcc quad_perm:[1,0,3,2] row_mask:0xf bank_mask:0xf
    v_cndmask_b32_dpp v21, v243, v241, vcc quad_perm:[1,0,3,2] row_mask:0xf bank_mask:0xf
    s_not_b64 vcc, vcc
    v_cndmask_b32_dpp v22, v240, v242, vcc quad_perm:[1,0,3,2] row_mask:0xf bank_mask:0xf
    v_cndmask_b32_dpp v23, v241, v243, vcc quad_perm:[1,0,3,2] row_mask:0xf bank_mask:0xf
    s_not_b64 vcc, vcc
    s_waitcnt vmcnt(8) lgkmcnt(15)
    v_mfma_f32_16x16x32_bf16 v[116:119], v[136:139], v[20:23], 0
    buffer_load_dwordx4 v[200:203], v1, s[12:15], s28 offen offset:2048 sc1
    v_cndmask_b32_dpp v240, v246, v244, vcc quad_perm:[1,0,3,2] row_mask:0xf bank_mask:0xf
    ds_read_b128 a[0:3], v12 offset:30720
    v_mfma_f32_16x16x32_bf16 v[120:123], v[140:143], v[20:23], 0
    buffer_load_dwordx4 v[204:207], v1, s[12:15], s28 offen offset:3072 sc1
    v_cndmask_b32_dpp v241, v247, v245, vcc quad_perm:[1,0,3,2] row_mask:0xf bank_mask:0xf
    s_not_b64 vcc, vcc
    ds_read_b128 a[4:7], v12 offset:31744
    v_mfma_f32_16x16x32_bf16 v[124:127], v[144:147], v[20:23], 0
    s_add_u32 s28, s28, 4096
    buffer_load_dwordx4 v[208:211], v1, s[12:15], s28 offen sc1
    v_cndmask_b32_dpp v242, v244, v246, vcc quad_perm:[1,0,3,2] row_mask:0xf bank_mask:0xf
    ds_read_b128 a[8:11], v12 offset:32768
    v_mfma_f32_16x16x32_bf16 v[128:131], v[148:151], v[20:23], 0
    v_cndmask_b32_dpp v243, v245, v247, vcc quad_perm:[1,0,3,2] row_mask:0xf bank_mask:0xf
    s_not_b64 vcc, vcc
    ds_read_b128 a[12:15], v12 offset:33792
    v_mfma_f32_16x16x32_bf16 v[132:135], v[152:155], v[20:23], 0
    ds_read_b128 a[16:19], v12 offset:34816
    s_waitcnt vmcnt(10)
    v_mfma_f32_16x16x32_bf16 v[116:119], v[156:159], v[240:243], v[116:119]
    buffer_load_dwordx4 v[212:215], v1, s[12:15], s28 offen offset:1024 sc1
    v_cndmask_b32_dpp v244, v250, v248, vcc quad_perm:[1,0,3,2] row_mask:0xf bank_mask:0xf
    ds_read_b128 v[136:139], v12 offset:35840
    v_mfma_f32_16x16x32_bf16 v[120:123], v[160:163], v[240:243], v[120:123]
    v_cndmask_b32_dpp v245, v251, v249, vcc quad_perm:[1,0,3,2] row_mask:0xf bank_mask:0xf
    s_not_b64 vcc, vcc
    ds_read_b128 v[140:143], v12 offset:36864
    v_mfma_f32_16x16x32_bf16 v[124:127], v[164:167], v[240:243], v[124:127]
    v_cndmask_b32_dpp v246, v248, v250, vcc quad_perm:[1,0,3,2] row_mask:0xf bank_mask:0xf
    ds_read_b128 v[144:147], v12 offset:37888
    v_mfma_f32_16x16x32_bf16 v[128:131], v[168:171], v[240:243], v[128:131]
    v_cndmask_b32_dpp v247, v249, v251, vcc quad_perm:[1,0,3,2] row_mask:0xf bank_mask:0xf
    s_not_b64 vcc, vcc
    ds_read_b128 v[148:151], v12 offset:38912
    v_mfma_f32_16x16x32_bf16 v[132:135], v[172:175], v[240:243], v[132:135]
    ds_read_b128 v[152:155], v12 offset:39936
    s_waitcnt vmcnt(10) lgkmcnt(5)
    v_mfma_f32_16x16x32_bf16 v[116:119], a[0:3], v[244:247], v[116:119]
    buffer_load_dwordx4 v[216:219], v1, s[12:15], s28 offen offset:2048 sc1
    v_cndmask_b32_dpp v248, v254, v252, vcc quad_perm:[1,0,3,2] row_mask:0xf bank_mask:0xf
    ds_read_b128 v[156:159], v8 offset:0
    v_mfma_f32_16x16x32_bf16 v[120:123], a[4:7], v[244:247], v[120:123]
    v_cndmask_b32_dpp v249, v255, v253, vcc quad_perm:[1,0,3,2] row_mask:0xf bank_mask:0xf
    s_not_b64 vcc, vcc
    ds_read_b128 v[160:163], v8 offset:1024
    v_mfma_f32_16x16x32_bf16 v[124:127], a[8:11], v[244:247], v[124:127]
    buffer_load_dwordx4 v[220:223], v1, s[12:15], s28 offen offset:3072 sc1
    v_cndmask_b32_dpp v250, v252, v254, vcc quad_perm:[1,0,3,2] row_mask:0xf bank_mask:0xf
    ds_read_b128 v[164:167], v8 offset:2048
    v_mfma_f32_16x16x32_bf16 v[128:131], a[12:15], v[244:247], v[128:131]
    v_cndmask_b32_dpp v251, v253, v255, vcc quad_perm:[1,0,3,2] row_mask:0xf bank_mask:0xf
    s_not_b64 vcc, vcc
    ds_read_b128 v[168:171], v8 offset:3072
    v_mfma_f32_16x16x32_bf16 v[132:135], a[16:19], v[244:247], v[132:135]
    ds_read_b128 v[172:175], v8 offset:4096
    s_waitcnt lgkmcnt(5)
    v_mfma_f32_16x16x32_bf16 v[116:119], v[136:139], v[248:251], v[116:119]
    ds_read_b128 a[0:3], v8 offset:5120
    v_mfma_f32_16x16x32_bf16 v[120:123], v[140:143], v[248:251], v[120:123]
    ds_read_b128 a[4:7], v8 offset:6144
    v_mfma_f32_16x16x32_bf16 v[124:127], v[144:147], v[248:251], v[124:127]
    s_add_u32 s28, s28, 4096
    buffer_load_dwordx4 v[224:227], v1, s[12:15], s28 offen sc1
    ds_read_b128 a[8:11], v8 offset:7168
    v_mfma_f32_16x16x32_bf16 v[128:131], v[148:151], v[248:251], v[128:131]
    ds_read_b128 a[12:15], v8 offset:8192
    v_mfma_f32_16x16x32_bf16 v[132:135], v[152:155], v[248:251], v[132:135]
    ds_read_b128 a[16:19], v8 offset:9216
    s_waitcnt vmcnt(12) lgkmcnt(5)
    v_mfma_f32_16x16x32_bf16 v[116:119], v[156:159], v[176:179], v[116:119]
    ds_read_b128 v[136:139], v8 offset:10240
    v_mfma_f32_16x16x32_bf16 v[120:123], v[160:163], v[176:179], v[120:123]
    buffer_load_dwordx4 v[228:231], v1, s[12:15], s28 offen offset:1024 sc1
    ds_read_b128 v[140:143], v8 offset:11264
    v_mfma_f32_16x16x32_bf16 v[124:127], v[164:167], v[176:179], v[124:127]
    ds_read_b128 v[144:147], v8 offset:12288
    v_mfma_f32_16x16x32_bf16 v[128:131], v[168:171], v[176:179], v[128:131]
    ds_read_b128 v[148:151], v8 offset:13312
    v_mfma_f32_16x16x32_bf16 v[132:135], v[172:175], v[176:179], v[132:135]
    ds_read_b128 v[152:155], v8 offset:14336
    s_waitcnt vmcnt(12) lgkmcnt(5)
    v_mfma_f32_16x16x32_bf16 v[116:119], a[0:3], v[180:183], v[116:119]
    ds_read_b128 v[156:159], v8 offset:15360
    v_mfma_f32_16x16x32_bf16 v[120:123], a[4:7], v[180:183], v[120:123]
    buffer_load_dwordx4 v[232:235], v1, s[12:15], s28 offen offset:2048 sc1
    ds_read_b128 v[160:163], v8 offset:16384
    v_mfma_f32_16x16x32_bf16 v[124:127], a[8:11], v[180:183], v[124:127]
    ds_read_b128 v[164:167], v8 offset:17408
    v_mfma_f32_16x16x32_bf16 v[128:131], a[12:15], v[180:183], v[128:131]
    ds_read_b128 v[168:171], v8 offset:18432
    v_mfma_f32_16x16x32_bf16 v[132:135], a[16:19], v[180:183], v[132:135]
    ds_read_b128 v[172:175], v8 offset:19456
    s_waitcnt vmcnt(12) lgkmcnt(5)
    v_mfma_f32_16x16x32_bf16 v[116:119], v[136:139], v[184:187], v[116:119]
    buffer_load_dwordx4 v[236:239], v1, s[12:15], s28 offen offset:3072 sc1
    ds_read_b128 a[0:3], v8 offset:20480
    v_mfma_f32_16x16x32_bf16 v[120:123], v[140:143], v[184:187], v[120:123]
    ds_read_b128 a[4:7], v8 offset:21504
    v_mfma_f32_16x16x32_bf16 v[124:127], v[144:147], v[184:187], v[124:127]
    ds_read_b128 a[8:11], v8 offset:22528
    v_mfma_f32_16x16x32_bf16 v[128:131], v[148:151], v[184:187], v[128:131]
    ds_read_b128 a[12:15], v8 offset:23552
    v_mfma_f32_16x16x32_bf16 v[132:135], v[152:155], v[184:187], v[132:135]
    ds_read_b128 a[16:19], v8 offset:24576
    s_waitcnt vmcnt(12) lgkmcnt(5)
    v_mfma_f32_16x16x32_bf16 v[116:119], v[156:159], v[188:191], v[116:119]
    buffer_load_dwordx4 a[20:23], v1, s[12:15], s65 offen offset:1024 sc1
    ds_read_b128 v[136:139], v8 offset:25600
    v_mfma_f32_16x16x32_bf16 v[120:123], v[160:163], v[188:191], v[120:123]
    ds_read_b128 v[140:143], v8 offset:26624
    v_mfma_f32_16x16x32_bf16 v[124:127], v[164:167], v[188:191], v[124:127]
    ds_read_b128 v[144:147], v8 offset:27648
    v_mfma_f32_16x16x32_bf16 v[128:131], v[168:171], v[188:191], v[128:131]
    ds_read_b128 v[148:151], v8 offset:28672
    v_mfma_f32_16x16x32_bf16 v[132:135], v[172:175], v[188:191], v[132:135]
    ds_read_b128 v[152:155], v8 offset:29696
    s_waitcnt vmcnt(12) lgkmcnt(5)
    v_mfma_f32_16x16x32_bf16 v[116:119], a[0:3], v[192:195], v[116:119]
    buffer_load_dwordx4 v7, s[12:15], s66 offen offset:2048 sc1 lds
    ds_read_b128 v[156:159], v8 offset:30720
    v_mfma_f32_16x16x32_bf16 v[120:123], a[4:7], v[192:195], v[120:123]
    ds_read_b128 v[160:163], v8 offset:31744
    v_mfma_f32_16x16x32_bf16 v[124:127], a[8:11], v[192:195], v[124:127]
    ds_read_b128 v[164:167], v8 offset:32768
    v_mfma_f32_16x16x32_bf16 v[128:131], a[12:15], v[192:195], v[128:131]
    ds_read_b128 v[168:171], v8 offset:33792
    v_mfma_f32_16x16x32_bf16 v[132:135], a[16:19], v[192:195], v[132:135]
    ds_read_b128 v[172:175], v8 offset:34816
    s_waitcnt vmcnt(12) lgkmcnt(5)
    v_mfma_f32_16x16x32_bf16 v[116:119], v[136:139], v[196:199], v[116:119]
    buffer_load_dwordx4 a[24:27], v1, s[12:15], s65 offen offset:2048 sc1
    ds_read_b128 a[0:3], v8 offset:35840
    v_mfma_f32_16x16x32_bf16 v[120:123], v[140:143], v[196:199], v[120:123]
    ds_read_b128 a[4:7], v8 offset:36864
    v_mfma_f32_16x16x32_bf16 v[124:127], v[144:147], v[196:199], v[124:127]
    ds_read_b128 a[8:11], v8 offset:37888
    v_mfma_f32_16x16x32_bf16 v[128:131], v[148:151], v[196:199], v[128:131]
    buffer_load_dwordx4 v7, s[12:15], s66 offen offset:3072 sc1 lds
    ds_read_b128 a[12:15], v8 offset:38912
    v_mfma_f32_16x16x32_bf16 v[132:135], v[152:155], v[196:199], v[132:135]
    ds_read_b128 a[16:19], v8 offset:39936
    s_waitcnt vmcnt(13) lgkmcnt(5)
    v_mfma_f32_16x16x32_bf16 v[116:119], v[156:159], v[200:203], v[116:119]
    ds_read_b128 v[136:139], v8 offset:40960
    v_mfma_f32_16x16x32_bf16 v[120:123], v[160:163], v[200:203], v[120:123]
    ds_read_b128 v[140:143], v8 offset:41984
    v_mfma_f32_16x16x32_bf16 v[124:127], v[164:167], v[200:203], v[124:127]
    ds_read_b128 v[144:147], v8 offset:43008
    v_mfma_f32_16x16x32_bf16 v[128:131], v[168:171], v[200:203], v[128:131]
    buffer_load_dwordx4 a[28:31], v1, s[12:15], s65 offen offset:3072 sc1
    ds_read_b128 v[148:151], v8 offset:44032
    v_mfma_f32_16x16x32_bf16 v[132:135], v[172:175], v[200:203], v[132:135]
    ds_read_b128 v[152:155], v8 offset:45056
    s_waitcnt vmcnt(13) lgkmcnt(5)
    v_mfma_f32_16x16x32_bf16 v[116:119], a[0:3], v[204:207], v[116:119]
    ds_read_b128 v[156:159], v8 offset:46080
    v_mfma_f32_16x16x32_bf16 v[120:123], a[4:7], v[204:207], v[120:123]
    ds_read_b128 v[160:163], v8 offset:47104
    v_mfma_f32_16x16x32_bf16 v[124:127], a[8:11], v[204:207], v[124:127]
    s_add_u32 s66, s66, 4096
    s_add_u32 m0, s60, 4096
    s_nop 0
    buffer_load_dwordx4 v7, s[12:15], s66 offen sc1 lds
    ds_read_b128 v[164:167], v8 offset:48128
    v_mfma_f32_16x16x32_bf16 v[128:131], a[12:15], v[204:207], v[128:131]
    ds_read_b128 v[168:171], v8 offset:49152
    v_mfma_f32_16x16x32_bf16 v[132:135], a[16:19], v[204:207], v[132:135]
    ds_read_b128 v[172:175], v8 offset:50176
    s_waitcnt vmcnt(13) lgkmcnt(5)
    v_mfma_f32_16x16x32_bf16 v[116:119], v[136:139], v[208:211], v[116:119]
    ds_read_b128 a[0:3], v8 offset:51200
    v_mfma_f32_16x16x32_bf16 v[120:123], v[140:143], v[208:211], v[120:123]
    s_add_u32 s65, s65, 4096
    buffer_load_dwordx4 a[32:35], v1, s[12:15], s65 offen sc1
    ds_read_b128 a[4:7], v8 offset:52224
    v_mfma_f32_16x16x32_bf16 v[124:127], v[144:147], v[208:211], v[124:127]
    ds_read_b128 a[8:11], v8 offset:53248
    v_mfma_f32_16x16x32_bf16 v[128:131], v[148:151], v[208:211], v[128:131]
    ds_read_b128 a[12:15], v8 offset:54272
    v_mfma_f32_16x16x32_bf16 v[132:135], v[152:155], v[208:211], v[132:135]
    ds_read_b128 a[16:19], v8 offset:55296
    s_waitcnt vmcnt(13) lgkmcnt(5)
    v_mfma_f32_16x16x32_bf16 v[116:119], v[156:159], v[212:215], v[116:119]
    ds_read_b128 v[136:139], v8 offset:56320
    v_mfma_f32_16x16x32_bf16 v[120:123], v[160:163], v[212:215], v[120:123]
    buffer_load_dwordx4 v7, s[12:15], s66 offen offset:1024 sc1 lds
    ds_read_b128 v[140:143], v8 offset:57344
    v_mfma_f32_16x16x32_bf16 v[124:127], v[164:167], v[212:215], v[124:127]
    ds_read_b128 v[144:147], v8 offset:58368
    v_mfma_f32_16x16x32_bf16 v[128:131], v[168:171], v[212:215], v[128:131]
    ds_read_b128 v[148:151], v8 offset:59392
    v_mfma_f32_16x16x32_bf16 v[132:135], v[172:175], v[212:215], v[132:135]
    ds_read_b128 v[152:155], v8 offset:60416
    s_waitcnt vmcnt(13) lgkmcnt(5)
    v_mfma_f32_16x16x32_bf16 v[116:119], a[0:3], v[216:219], v[116:119]
    buffer_load_dwordx4 a[36:39], v1, s[12:15], s65 offen offset:1024 sc1
    ds_read_b128 v[156:159], v12 offset:0
    v_mfma_f32_16x16x32_bf16 v[120:123], a[4:7], v[216:219], v[120:123]
    ds_read_b128 v[160:163], v12 offset:1024
    v_mfma_f32_16x16x32_bf16 v[124:127], a[8:11], v[216:219], v[124:127]
    ds_read_b128 v[164:167], v12 offset:2048
    v_mfma_f32_16x16x32_bf16 v[128:131], a[12:15], v[216:219], v[128:131]
    ds_read_b128 v[168:171], v12 offset:3072
    v_mfma_f32_16x16x32_bf16 v[132:135], a[16:19], v[216:219], v[132:135]
    ds_read_b128 v[172:175], v12 offset:4096
    s_waitcnt vmcnt(13) lgkmcnt(5)
    v_mfma_f32_16x16x32_bf16 v[116:119], v[136:139], v[220:223], v[116:119]
    buffer_load_dwordx4 v7, s[12:15], s66 offen offset:2048 sc1 lds
    ds_read_b128 a[0:3], v12 offset:5120
    v_mfma_f32_16x16x32_bf16 v[120:123], v[140:143], v[220:223], v[120:123]
    ds_read_b128 a[4:7], v12 offset:6144
    v_mfma_f32_16x16x32_bf16 v[124:127], v[144:147], v[220:223], v[124:127]
    ds_read_b128 a[8:11], v12 offset:7168
    v_mfma_f32_16x16x32_bf16 v[128:131], v[148:151], v[220:223], v[128:131]
    ds_read_b128 a[12:15], v12 offset:8192
    v_mfma_f32_16x16x32_bf16 v[132:135], v[152:155], v[220:223], v[132:135]
    ds_read_b128 a[16:19], v12 offset:9216
    s_waitcnt vmcnt(13) lgkmcnt(5)
    v_mfma_f32_16x16x32_bf16 v[116:119], v[156:159], v[224:227], v[116:119]
    ds_read_b128 v[136:139], v12 offset:10240
    v_mfma_f32_16x16x32_bf16 v[120:123], v[160:163], v[224:227], v[120:123]
    ds_read_b128 v[140:143], v12 offset:11264
    v_mfma_f32_16x16x32_bf16 v[124:127], v[164:167], v[224:227], v[124:127]
    buffer_load_dwordx4 a[40:43], v1, s[12:15], s65 offen offset:2048 sc1
    ds_read_b128 v[144:147], v12 offset:12288
    v_mfma_f32_16x16x32_bf16 v[128:131], v[168:171], v[224:227], v[128:131]
    ds_read_b128 v[148:151], v12 offset:13312
    v_mfma_f32_16x16x32_bf16 v[132:135], v[172:175], v[224:227], v[132:135]
    ds_read_b128 v[152:155], v12 offset:14336
    s_waitcnt vmcnt(13) lgkmcnt(5)
    v_mfma_f32_16x16x32_bf16 v[116:119], a[0:3], v[228:231], v[116:119]
    ds_read_b128 v[156:159], v12 offset:15360
    v_mfma_f32_16x16x32_bf16 v[120:123], a[4:7], v[228:231], v[120:123]
    ds_read_b128 v[160:163], v12 offset:16384
    v_mfma_f32_16x16x32_bf16 v[124:127], a[8:11], v[228:231], v[124:127]
    buffer_load_dwordx4 v7, s[12:15], s66 offen offset:3072 sc1 lds
    ds_read_b128 v[164:167], v12 offset:17408
    v_mfma_f32_16x16x32_bf16 v[128:131], a[12:15], v[228:231], v[128:131]
    ds_read_b128 v[168:171], v12 offset:18432
    v_mfma_f32_16x16x32_bf16 v[132:135], a[16:19], v[228:231], v[132:135]
    ds_read_b128 v[172:175], v12 offset:19456
    s_waitcnt vmcnt(13) lgkmcnt(5)
    v_mfma_f32_16x16x32_bf16 v[116:119], v[136:139], v[232:235], v[116:119]
    v_mfma_f32_16x16x32_bf16 v[120:123], v[140:143], v[232:235], v[120:123]
    v_mfma_f32_16x16x32_bf16 v[124:127], v[144:147], v[232:235], v[124:127]
    buffer_load_dwordx4 a[44:47], v1, s[12:15], s65 offen offset:3072 sc1
    v_mfma_f32_16x16x32_bf16 v[128:131], v[148:151], v[232:235], v[128:131]
    v_mfma_f32_16x16x32_bf16 v[132:135], v[152:155], v[232:235], v[132:135]
    s_waitcnt vmcnt(13) lgkmcnt(0)
    v_mfma_f32_16x16x32_bf16 v[116:119], v[156:159], v[236:239], v[116:119]
    v_mfma_f32_16x16x32_bf16 v[120:123], v[160:163], v[236:239], v[120:123]
    v_mfma_f32_16x16x32_bf16 v[124:127], v[164:167], v[236:239], v[124:127]
    s_add_u32 s66, s66, 4096
    s_add_u32 m0, s60, 8192
    s_nop 0
    buffer_load_dwordx4 v7, s[12:15], s66 offen sc1 lds
    v_mfma_f32_16x16x32_bf16 v[128:131], v[168:171], v[236:239], v[128:131]
    v_mfma_f32_16x16x32_bf16 v[132:135], v[172:175], v[236:239], v[132:135]
    v_pk_fma_f32 v[96:97], v[116:117], v[76:77], v[96:97]
    v_pk_fma_f32 v[98:99], v[118:119], v[78:79], v[98:99]
    v_pk_fma_f32 v[100:101], v[120:121], v[80:81], v[100:101]
    v_pk_fma_f32 v[102:103], v[122:123], v[82:83], v[102:103]
    v_pk_fma_f32 v[104:105], v[124:125], v[84:85], v[104:105]
    v_pk_fma_f32 v[106:107], v[126:127], v[86:87], v[106:107]
    s_nop 0
    v_pk_fma_f32 v[108:109], v[128:129], v[88:89], v[108:109]
    v_pk_fma_f32 v[110:111], v[130:131], v[90:91], v[110:111]
    v_pk_fma_f32 v[112:113], v[132:133], v[92:93], v[112:113]
    v_pk_fma_f32 v[114:115], v[134:135], v[94:95], v[114:115]
    v_pk_add_f32 v[20:21], v[96:97], v[98:99]
    v_pk_mul_f32 v[18:19], v[96:97], v[96:97]
    v_pk_fma_f32 v[18:19], v[98:99], v[98:99], v[18:19]
    v_pk_add_f32 v[20:21], v[20:21], v[100:101]
    v_pk_fma_f32 v[18:19], v[100:101], v[100:101], v[18:19]
    v_pk_add_f32 v[20:21], v[20:21], v[102:103]
    v_pk_fma_f32 v[18:19], v[102:103], v[102:103], v[18:19]
    v_pk_add_f32 v[20:21], v[20:21], v[104:105]
    v_pk_fma_f32 v[18:19], v[104:105], v[104:105], v[18:19]
    v_pk_add_f32 v[20:21], v[20:21], v[106:107]
    v_pk_fma_f32 v[18:19], v[106:107], v[106:107], v[18:19]
    v_pk_add_f32 v[20:21], v[20:21], v[108:109]
    v_pk_fma_f32 v[18:19], v[108:109], v[108:109], v[18:19]
    v_pk_add_f32 v[20:21], v[20:21], v[110:111]
    v_pk_fma_f32 v[18:19], v[110:111], v[110:111], v[18:19]
    v_pk_add_f32 v[20:21], v[20:21], v[112:113]
    v_pk_fma_f32 v[18:19], v[112:113], v[112:113], v[18:19]
    v_pk_add_f32 v[20:21], v[20:21], v[114:115]
    v_pk_fma_f32 v[18:19], v[114:115], v[114:115], v[18:19]
    v_add_f32 v16, v20, v21
    v_add_f32 v18, v18, v19
    v_cvt_pk_bf16_f32 v76, v96, v97
    v_accvgpr_write_b32 a244, v76
    v_permlane32_swap_b32 v16, v18
    v_add_f32 v19, v16, v18
    v_add_f32 v16, v16, v18
    v_cvt_pk_bf16_f32 v77, v98, v99
    v_accvgpr_write_b32 a245, v77
    v_permlane16_swap_b32 v16, v19
    v_add_f32 v16, v16, v19
    s_cmp_eq_u32 s59, 1
    s_cbranch_scc0 L_slow_38
    buffer_store_dwordx2 v[16:17], v30, s[12:15], s31 offen
L_back_39:
    s_barrier
    v_cvt_pk_bf16_f32 v78, v100, v101
    v_accvgpr_write_b32 a246, v78
    v_cvt_pk_bf16_f32 v79, v102, v103
    v_accvgpr_write_b32 a247, v79
    v_cvt_pk_bf16_f32 v80, v104, v105
    v_accvgpr_write_b32 a248, v80
    v_cvt_pk_bf16_f32 v81, v106, v107
    v_accvgpr_write_b32 a249, v81
    v_cvt_pk_bf16_f32 v82, v108, v109
    v_accvgpr_write_b32 a250, v82
    v_cvt_pk_bf16_f32 v83, v110, v111
    v_accvgpr_write_b32 a251, v83
    v_cvt_pk_bf16_f32 v84, v112, v113
    v_accvgpr_write_b32 a252, v84
    v_cvt_pk_bf16_f32 v85, v114, v115
    v_accvgpr_write_b32 a253, v85
    s_lshl_b32 s28, s56, 3
    s_lshr_b32 s5, s52, 1
    s_lshl_b32 s75, s5, 2
    s_add_u32 s28, s28, s75
    s_and_b32 s75, s52, 1
    s_add_u32 s28, s28, s75
    s_mul_i32 s28, s28, 20480
    s_add_u32 s28, s28, 10027008
    s_add_u32 s0, s28, 40960
    s_mul_i32 s74, s52, 24576
    s_mul_i32 s5, s5, 20480
    s_add_u32 s5, s5, 0
    v_add_u32 v10, s5, v1
    s_mul_i32 s5, s75, 49152
    s_add_u32 s76, s5, 40960
    v_add_u32 v8, s76, v1
    s_sub_u32 s5, 90112, s5
    v_add_u32 v9, s5, v1
    buffer_load_dwordx4 v[20:23], v31, s[12:15], s30 offen offset:0 sc1
    buffer_load_dwordx4 v[24:27], v31, s[12:15], s30 offen offset:512 sc1
    s_mov_b32 s3, 0
    s_branch L_first_41
L_retry_40:
    s_waitcnt lgkmcnt(0)
    s_add_u32 s3, s3, 1
    s_cmp_gt_u32 s3, 0x20000
    s_cbranch_scc1 L_done_42
    buffer_load_dwordx4 v[20:23], v31, s[12:15], s30 offen offset:0 sc1
    buffer_load_dwordx4 v[24:27], v31, s[12:15], s30 offen offset:512 sc1
    s_waitcnt vmcnt(0)
L_first_41:
    s_waitcnt vmcnt(1)
    v_xor_b32 v28, v21, v17
    v_bitop3_b32 v28, v28, v23, v17 bitop3:0xf6
    s_waitcnt vmcnt(0)
    v_bitop3_b32 v28, v28, v25, v17 bitop3:0xf6
    v_bitop3_b32 v28, v28, v27, v17 bitop3:0xf6
    v_cmp_ne_u32 vcc, 0, v28
    s_cbranch_vccnz L_retry_40
L_done_42:
    v_add_f32 v20, v20, v22
    v_add_f32 v24, v24, v26
    v_add_f32 v22, v20, v24
    v_add_f32 v20, v20, v24
    s_nop 1
    v_permlane16_swap_b32 v20, v22
    v_add_f32 v21, v20, v22
    v_add_f32 v20, v20, v22
    s_nop 1
    v_permlane32_swap_b32 v20, v21
    v_mul_f32 v20, s4, v20
    v_mul_f32 v21, s4, v21
    v_fma_f32 v21, -v20, v20, v21
    v_max_f32 v21, 0, v21
    v_add_f32 v21, 0x3727c5ac, v21
    v_rsq_f32 v22, v21
    s_nop 0
    v_mul_f32 v23, -v20, v22
    v_pk_fma_f32 v[96:97], v[96:97], v[22:23], v[22:23] op_sel:[0,0,1] op_sel_hi:[1,0,1]
    v_pk_fma_f32 v[98:99], v[98:99], v[22:23], v[22:23] op_sel:[0,0,1] op_sel_hi:[1,0,1]
    v_pk_fma_f32 v[100:101], v[100:101], v[22:23], v[22:23] op_sel:[0,0,1] op_sel_hi:[1,0,1]
    v_pk_fma_f32 v[102:103], v[102:103], v[22:23], v[22:23] op_sel:[0,0,1] op_sel_hi:[1,0,1]
    v_pk_fma_f32 v[104:105], v[104:105], v[22:23], v[22:23] op_sel:[0,0,1] op_sel_hi:[1,0,1]
    v_pk_fma_f32 v[106:107], v[106:107], v[22:23], v[22:23] op_sel:[0,0,1] op_sel_hi:[1,0,1]
    v_pk_fma_f32 v[108:109], v[108:109], v[22:23], v[22:23] op_sel:[0,0,1] op_sel_hi:[1,0,1]
    v_pk_fma_f32 v[110:111], v[110:111], v[22:23], v[22:23] op_sel:[0,0,1] op_sel_hi:[1,0,1]
    v_pk_fma_f32 v[112:113], v[112:113], v[22:23], v[22:23] op_sel:[0,0,1] op_sel_hi:[1,0,1]
    v_pk_fma_f32 v[114:115], v[114:115], v[22:23], v[22:23] op_sel:[0,0,1] op_sel_hi:[1,0,1]
    v_pk_fma_f32 v[96:97], v[96:97], v[36:37], v[56:57]
    v_pk_fma_f32 v[98:99], v[98:99], v[38:39], v[58:59]
    v_pk_fma_f32 v[100:101], v[100:101], v[40:41], v[60:61]
    v_pk_fma_f32 v[102:103], v[102:103], v[42:43], v[62:63]
    v_pk_fma_f32 v[104:105], v[104:105], v[44:45], v[64:65]
    v_pk_fma_f32 v[106:107], v[106:107], v[46:47], v[66:67]
    v_pk_fma_f32 v[108:109], v[108:109], v[48:49], v[68:69]
    v_pk_fma_f32 v[110:111], v[110:111], v[50:51], v[70:71]
    v_pk_fma_f32 v[112:113], v[112:113], v[52:53], v[72:73]
    v_pk_fma_f32 v[114:115], v[114:115], v[54:55], v[74:75]
    v_cvt_pk_bf16_f32 v24, v112, v113
    v_mov_b32 v26, v24
    v_cvt_pk_bf16_f32 v25, v114, v115
    v_mov_b32 v27, v25
    v_cvt_pk_bf16_f32 v16, v96, v97
    v_cvt_pk_bf16_f32 v17, v98, v99
    v_cvt_pk_bf16_f32 v18, v100, v101
    v_cvt_pk_bf16_f32 v19, v102, v103
    v_cvt_pk_bf16_f32 v20, v104, v105
    v_cvt_pk_bf16_f32 v21, v106, v107
    v_cvt_pk_bf16_f32 v22, v108, v109
    v_cvt_pk_bf16_f32 v23, v110, v111
    v_permlane32_swap_b32 v24, v26
    v_permlane32_swap_b32 v25, v27
    s_cmp_eq_u32 s59, 1
    s_cbranch_scc0 L_slow_43
    buffer_store_dwordx4 v[16:19], v1, s[12:15], s72 offen
    buffer_store_dwordx4 v[20:23], v1, s[12:15], s72 offen offset:1024
    buffer_store_dwordx4 v[24:27], v32, s[12:15], s73 offen offset:2048
L_back_44:
    s_add_u32 s65, s65, 4096
    buffer_load_dwordx4 a[48:51], v1, s[12:15], s65 offen sc1
    buffer_load_dwordx4 v7, s[12:15], s66 offen offset:1024 sc1 lds
    buffer_load_dwordx4 a[52:55], v1, s[12:15], s65 offen offset:1024 sc1
    s_waitcnt vmcnt(3)
    s_cmp_eq_u32 s59, 1
    s_cbranch_scc0 L_slow_45
    buffer_store_dword v15, v14, s[12:15], s33 offen
L_back_46:
    buffer_load_dwordx4 a[56:59], v1, s[12:15], s64 offen offset:3072 sc1
    buffer_load_dwordx4 a[60:63], v1, s[12:15], s65 offen offset:2048 sc1
    buffer_load_dwordx4 a[88:91], v5, s[12:15], s64 offen offset:3072 sc1
    buffer_load_dwordx4 a[92:95], v1, s[12:15], s65 offen offset:3072 sc1
    buffer_load_dwordx4 a[96:99], v6, s[12:15], s64 offen offset:3072 sc1
    s_load_dwordx16 s[36:51], s[34:35], s32
    s_add_u32 s65, s65, 4096
    buffer_load_dwordx4 a[100:103], v1, s[12:15], s65 offen sc1
    s_add_u32 s64, s64, 4096
    buffer_load_dwordx4 a[64:67], v1, s[12:15], s64 offen sc1
    buffer_load_dwordx4 a[68:71], v1, s[12:15], s65 offen offset:1024 sc1
    s_mov_b32 s3, 0
    s_branch L_first_48
L_retry_47:
    s_waitcnt lgkmcnt(0)
    s_add_u32 s3, s3, 1
    s_cmp_gt_u32 s3, 0x20000
    s_cbranch_scc1 L_done_49
    s_cmp_lt_u32 s3, 16
    s_cbranch_scc0 L_coherent_50
    s_add_u32 s32, s32, 64
    s_load_dwordx16 s[36:51], s[34:35], s32
L_back_51:
L_first_48:
    s_waitcnt lgkmcnt(0)
    s_cmp_lg_u64 s[36:37], s[6:7]
    s_cbranch_scc1 L_retry_47
    s_cmp_lg_u64 s[38:39], s[6:7]
    s_cbranch_scc1 L_retry_47
    s_cmp_lg_u64 s[40:41], s[6:7]
    s_cbranch_scc1 L_retry_47
    s_cmp_lg_u64 s[42:43], s[6:7]
    s_cbranch_scc1 L_retry_47
    s_cmp_lg_u64 s[44:45], s[6:7]
    s_cbranch_scc1 L_retry_47
    s_cmp_lg_u64 s[46:47], s[6:7]
    s_cbranch_scc1 L_retry_47
    s_cmp_lg_u64 s[48:49], s[6:7]
    s_cbranch_scc1 L_retry_47
    s_cmp_lg_u64 s[50:51], s[6:7]
    s_cbranch_scc1 L_retry_47
L_done_49:
    s_add_u32 m0, s74, 40960
    s_nop 0
    buffer_load_dwordx4 v1, s[12:15], s28 offen sc1 lds
    s_add_u32 m0, s74, 53248
    s_nop 0
    buffer_load_dwordx4 v1, s[12:15], s0 offen sc1 lds
    s_add_u32 m0, s74, 40960
    s_nop 0
    buffer_load_dwordx4 v1, s[12:15], s28 offen offset:1024 sc1 lds
    s_add_u32 m0, s74, 53248
    s_nop 0
    buffer_load_dwordx4 v1, s[12:15], s0 offen offset:1024 sc1 lds
    s_add_u32 m0, s74, 40960
    s_nop 0
    buffer_load_dwordx4 v1, s[12:15], s28 offen offset:2048 sc1 lds
    buffer_load_dwordx4 v1, s[12:15], s28 offen offset:3072 sc1 lds
    s_add_u32 m0, s74, 53248
    s_nop 0
    buffer_load_dwordx4 v1, s[12:15], s0 offen offset:2048 sc1 lds
    buffer_load_dwordx4 v1, s[12:15], s0 offen offset:3072 sc1 lds
    s_add_u32 s28, s28, 4096
    s_add_u32 m0, s74, 45056
    s_nop 0
    buffer_load_dwordx4 v1, s[12:15], s28 offen sc1 lds
    buffer_load_dwordx4 v1, s[12:15], s28 offen offset:1024 sc1 lds
    s_add_u32 s0, s0, 4096
    s_add_u32 m0, s74, 57344
    s_nop 0
    buffer_load_dwordx4 v1, s[12:15], s0 offen sc1 lds
    s_waitcnt vmcnt(10)
    s_barrier
    ds_read_b128 v[32:35], v10 offset:0
    ds_read_b128 v[16:19], v8 offset:0
    ds_read_b128 v[20:23], v8 offset:24576
    ds_read_b128 v[24:27], v9 offset:0
    ds_read_b128 v[28:31], v9 offset:24576
    buffer_load_dwordx4 v1, s[12:15], s0 offen offset:1024 sc1 lds
    s_waitcnt vmcnt(10)
    s_barrier
    s_waitcnt lgkmcnt(3)
    v_mfma_f32_16x16x32_bf16 v[144:147], a[204:207], v[16:19], 0
    s_getpc_b64 s[4:5]
L_pc3:
    v_mfma_f32_16x16x32_bf16 v[160:163], a[208:211], v[16:19], 0
    buffer_load_dwordx4 a[104:107], v5, s[12:15], s64 offen sc1
    v_mfma_f32_16x16x32_bf16 v[176:179], a[212:215], v[16:19], 0
    s_sub_u32 s4, s4, L_pc3-L_begin
    s_subb_u32 s5, s5, 0
    s_mov_b32 s6, L_last-L_begin
    v_mfma_f32_16x16x32_bf16 v[192:195], v[32:35], v[16:19], 0
    ds_read_b128 v[16:19], v8 offset:12288
    s_waitcnt lgkmcnt(3)
    v_mfma_f32_16x16x32_bf16 v[148:151], a[204:207], v[20:23], 0
    s_mov_b32 s7, 0x20000
    s_lshr_b32 s3, s2, 3
    s_lshl_b32 s3, s3, 7
    v_mfma_f32_16x16x32_bf16 v[164:167], a[208:211], v[20:23], 0
    buffer_load_dwordx4 a[108:111], v6, s[12:15], s64 offen sc1
    v_mfma_f32_16x16x32_bf16 v[180:183], a[212:215], v[20:23], 0
    s_add_u32 s3, s3, 28672
    v_min_u32 v2, 3, v0
    v_mfma_f32_16x16x32_bf16 v[196:199], v[32:35], v[20:23], 0
    ds_read_b128 v[20:23], v8 offset:36864
    s_waitcnt lgkmcnt(3)
    v_mfma_f32_16x16x32_bf16 v[152:155], a[204:207], v[24:27], 0
    buffer_load_dwordx4 a[112:115], v1, s[12:15], s64 offen offset:1024 sc1
    v_mfma_f32_16x16x32_bf16 v[168:171], a[208:211], v[24:27], 0
    v_lshlrev_b32 v2, 12, v2
    v_add_u32 v2, s3, v2
    v_mfma_f32_16x16x32_bf16 v[184:187], a[212:215], v[24:27], 0
    ds_read_b128 v[24:27], v9 offset:12288
    s_waitcnt lgkmcnt(3)
    v_mfma_f32_16x16x32_bf16 v[156:159], a[204:207], v[28:31], 0
    buffer_load_dword v2, v2, s[4:7], 0 offen
    s_and_b32 s4, s52, 1
    v_mfma_f32_16x16x32_bf16 v[172:175], a[208:211], v[28:31], 0
    s_lshl_b32 s4, s4, 1
    v_xor_b32 v11, s4, v4
    v_mfma_f32_16x16x32_bf16 v[188:191], a[212:215], v[28:31], 0
    ds_read_b128 v[28:31], v9 offset:36864
    s_waitcnt vmcnt(12)
    s_barrier
    s_waitcnt lgkmcnt(3)
    v_mfma_f32_16x16x32_bf16 v[200:203], a[204:207], v[16:19], 0
    v_and_b32 v12, 1, v11
    v_lshrrev_b32 v11, 1, v11
    v_mfma_f32_16x16x32_bf16 v[216:219], a[208:211], v[16:19], 0
    buffer_load_dwordx4 a[116:119], v5, s[12:15], s64 offen offset:1024 sc1
    v_mfma_f32_16x16x32_bf16 v[232:235], a[212:215], v[16:19], 0
    v_lshl_add_u32 v11, v11, 2, v12
    v_mul_u32_u24 v11, 55296, v11
    v_mfma_f32_16x16x32_bf16 v[248:251], v[32:35], v[16:19], 0
    ds_read_b128 v[16:19], v8 offset:1024
    s_waitcnt lgkmcnt(3)
    v_mfma_f32_16x16x32_bf16 v[204:207], a[204:207], v[20:23], 0
    v_lshl_add_u32 v11, v3, 4, v11
    v_mfma_f32_16x16x32_bf16 v[220:223], a[208:211], v[20:23], 0
    buffer_load_dwordx4 a[72:75], v6, s[12:15], s64 offen offset:1024 sc1
    v_mfma_f32_16x16x32_bf16 v[236:239], a[212:215], v[20:23], 0
    s_cmp_ge_u32 s55, 12
    s_cselect_b32 s4, 0x80000000, 0
    v_mfma_f32_16x16x32_bf16 v[252:255], v[32:35], v[20:23], 0
    ds_read_b128 v[20:23], v8 offset:25600
    s_waitcnt lgkmcnt(3)
    v_mfma_f32_16x16x32_bf16 v[208:211], a[204:207], v[24:27], 0
    v_lshlrev_b32 v12, 26, v0
    v_and_b32 v12, 0x80000000, v12
    v_mfma_f32_16x16x32_bf16 v[224:227], a[208:211], v[24:27], 0
    s_add_u32 m0, s74, 45056
    s_nop 0
    buffer_load_dwordx4 v1, s[12:15], s28 offen offset:2048 sc1 lds
    v_mfma_f32_16x16x32_bf16 v[240:243], a[212:215], v[24:27], 0
    ds_read_b128 v[24:27], v9 offset:1024
    ds_read_b128 v[32:35], v10 offset:1024
    s_waitcnt lgkmcnt(4)
    v_mfma_f32_16x16x32_bf16 v[212:215], a[204:207], v[28:31], 0
    v_or3_b32 v12, v12, s4, v11
    s_mul_i32 s31, s56, 442368
    v_mfma_f32_16x16x32_bf16 v[228:231], a[208:211], v[28:31], 0
    buffer_load_dwordx4 v1, s[12:15], s28 offen offset:3072 sc1 lds
    v_mfma_f32_16x16x32_bf16 v[244:247], a[212:215], v[28:31], 0
    ds_read_b128 v[28:31], v9 offset:25600
    s_waitcnt lgkmcnt(4)
    v_mfma_f32_16x16x32_bf16 v[144:147], a[216:219], v[16:19], v[144:147]
    s_add_u32 s31, s31, 15269888
    s_lshl_b32 s4, s55, 2
    s_add_u32 s4, s4, s52
    v_mfma_f32_16x16x32_bf16 v[160:163], a[220:223], v[16:19], v[160:163]
    s_mul_i32 s5, s4, 768
    s_add_u32 s29, s31, s5
    s_lshr_b32 s5, s4, 1
    v_mfma_f32_16x16x32_bf16 v[176:179], a[224:227], v[16:19], v[176:179]
    s_add_u32 m0, s74, 57344
    s_nop 0
    buffer_load_dwordx4 v1, s[12:15], s0 offen offset:2048 sc1 lds
    s_waitcnt lgkmcnt(1)
    v_mfma_f32_16x16x32_bf16 v[192:195], v[32:35], v[16:19], v[192:195]
    ds_read_b128 v[16:19], v8 offset:13312
    v_mfma_f32_16x16x32_bf16 v[148:151], a[216:219], v[20:23], v[148:151]
    s_add_u32 s5, s5, 192
    s_lshl_b32 s5, s5, 8
    s_add_u32 s31, s31, s5
    v_mfma_f32_16x16x32_bf16 v[164:167], a[220:223], v[20:23], v[164:167]
    buffer_load_dwordx4 v1, s[12:15], s0 offen offset:3072 sc1 lds
    v_mfma_f32_16x16x32_bf16 v[180:183], a[224:227], v[20:23], v[180:183]
    s_lshl_b32 s32, s56, 12
    s_add_u32 s32, s32, 262144
    s_lshl_b32 s4, s4, 6
    v_mfma_f32_16x16x32_bf16 v[196:199], v[32:35], v[20:23], v[196:199]
    ds_read_b128 v[20:23], v8 offset:37888
    v_mfma_f32_16x16x32_bf16 v[152:155], a[216:219], v[24:27], v[152:155]
    s_add_u32 s4, s4, s32
    s_add_u32 s4, s4, 22675456
    v_mfma_f32_16x16x32_bf16 v[168:171], a[220:223], v[24:27], v[168:171]
    v_mov_b32 v14, 0
    buffer_load_dword v7, v14, s[12:15], s4 offen
    v_mfma_f32_16x16x32_bf16 v[184:187], a[224:227], v[24:27], v[184:187]
    ds_read_b128 v[24:27], v9 offset:13312
    s_waitcnt lgkmcnt(3)
    v_mfma_f32_16x16x32_bf16 v[156:159], a[216:219], v[28:31], v[156:159]
    s_lshl_b32 s33, s55, 2
    s_add_u32 s33, s33, s32
    s_add_u32 s33, s33, 22675456
    v_mfma_f32_16x16x32_bf16 v[172:175], a[220:223], v[28:31], v[172:175]
    s_lshl_b32 s4, s52, 28
    v_lshlrev_b32 v14, 26, v0
    v_mfma_f32_16x16x32_bf16 v[188:191], a[224:227], v[28:31], v[188:191]
    ds_read_b128 v[28:31], v9 offset:37888
    s_waitcnt vmcnt(15)
    s_barrier
    s_waitcnt lgkmcnt(3)
    v_mfma_f32_16x16x32_bf16 v[200:203], a[216:219], v[16:19], v[200:203]
    v_and_b32 v14, 0x80000000, v14
    v_lshl_add_u32 v14, v0, 7, v14
    v_mfma_f32_16x16x32_bf16 v[216:219], a[220:223], v[16:19], v[216:219]
    buffer_load_dwordx4 a[76:79], v1, s[12:15], s64 offen offset:2048 sc1
    v_mfma_f32_16x16x32_bf16 v[232:235], a[224:227], v[16:19], v[232:235]
    v_or_b32 v14, s4, v14
    v_mov_b32 v15, s58
    v_mfma_f32_16x16x32_bf16 v[248:251], v[32:35], v[16:19], v[248:251]
    ds_read_b128 v[16:19], v8 offset:2048
    s_waitcnt lgkmcnt(3)
    v_mfma_f32_16x16x32_bf16 v[204:207], a[216:219], v[20:23], v[204:207]
    s_mov_b32 s6, s58
    s_mov_b32 s7, s58
    s_mul_i32 s1, s54, 221184
    v_mfma_f32_16x16x32_bf16 v[220:223], a[220:223], v[20:23], v[220:223]
    s_lshl_b32 s4, s68, 10
    s_add_u32 s1, s1, s4
    s_add_u32 s1, s1, 15269888
    v_mfma_f32_16x16x32_bf16 v[236:239], a[224:227], v[20:23], v[236:239]
    buffer_load_dwordx4 a[120:123], v5, s[12:15], s64 offen offset:2048 sc1
    v_mfma_f32_16x16x32_bf16 v[252:255], v[32:35], v[20:23], v[252:255]
    ds_read_b128 v[20:23], v8 offset:26624
    s_waitcnt lgkmcnt(3)
    v_mfma_f32_16x16x32_bf16 v[208:211], a[216:219], v[24:27], v[208:211]
    v_mfma_f32_16x16x32_bf16 v[224:227], a[220:223], v[24:27], v[224:227]
    v_mfma_f32_16x16x32_bf16 v[240:243], a[224:227], v[24:27], v[240:243]
    ds_read_b128 v[24:27], v9 offset:2048
    ds_read_b128 v[32:35], v10 offset:2048
    s_waitcnt lgkmcnt(4)
    v_mfma_f32_16x16x32_bf16 v[212:215], a[216:219], v[28:31], v[212:215]
    v_mfma_f32_16x16x32_bf16 v[228:231], a[220:223], v[28:31], v[228:231]
    v_mfma_f32_16x16x32_bf16 v[244:247], a[224:227], v[28:31], v[244:247]
    ds_read_b128 v[28:31], v9 offset:26624
    s_waitcnt lgkmcnt(4)
    v_mfma_f32_16x16x32_bf16 v[144:147], a[228:231], v[16:19], v[144:147]
    v_mfma_f32_16x16x32_bf16 v[160:163], a[232:235], v[16:19], v[160:163]
    v_mfma_f32_16x16x32_bf16 v[176:179], a[236:239], v[16:19], v[176:179]
    s_waitcnt lgkmcnt(1)
    v_mfma_f32_16x16x32_bf16 v[192:195], v[32:35], v[16:19], v[192:195]
    ds_read_b128 v[16:19], v8 offset:14336
    v_mfma_f32_16x16x32_bf16 v[148:151], a[228:231], v[20:23], v[148:151]
    v_mfma_f32_16x16x32_bf16 v[164:167], a[232:235], v[20:23], v[164:167]
    v_mfma_f32_16x16x32_bf16 v[180:183], a[236:239], v[20:23], v[180:183]
    v_mfma_f32_16x16x32_bf16 v[196:199], v[32:35], v[20:23], v[196:199]
    ds_read_b128 v[20:23], v8 offset:38912
    v_mfma_f32_16x16x32_bf16 v[152:155], a[228:231], v[24:27], v[152:155]
    v_mfma_f32_16x16x32_bf16 v[168:171], a[232:235], v[24:27], v[168:171]
    v_mfma_f32_16x16x32_bf16 v[184:187], a[236:239], v[24:27], v[184:187]
    ds_read_b128 v[24:27], v9 offset:14336
    s_waitcnt lgkmcnt(3)
    v_mfma_f32_16x16x32_bf16 v[156:159], a[228:231], v[28:31], v[156:159]
    buffer_load_dwordx4 a[124:127], v6, s[12:15], s64 offen offset:2048 sc1
    v_mfma_f32_16x16x32_bf16 v[172:175], a[232:235], v[28:31], v[172:175]
    v_mfma_f32_16x16x32_bf16 v[188:191], a[236:239], v[28:31], v[188:191]
    ds_read_b128 v[28:31], v9 offset:38912
    s_waitcnt lgkmcnt(3)
    v_mfma_f32_16x16x32_bf16 v[200:203], a[228:231], v[16:19], v[200:203]
    buffer_load_dwordx4 a[128:131], v1, s[12:15], s64 offen offset:3072 sc1
    v_mfma_f32_16x16x32_bf16 v[216:219], a[232:235], v[16:19], v[216:219]
    v_mfma_f32_16x16x32_bf16 v[232:235], a[236:239], v[16:19], v[232:235]
    v_mfma_f32_16x16x32_bf16 v[248:251], v[32:35], v[16:19], v[248:251]
    ds_read_b128 v[16:19], v8 offset:3072
    s_waitcnt lgkmcnt(3)
    v_mfma_f32_16x16x32_bf16 v[204:207], a[228:231], v[20:23], v[204:207]
    buffer_load_dwordx4 a[132:135], v5, s[12:15], s64 offen offset:3072 sc1
    v_mfma_f32_16x16x32_bf16 v[220:223], a[232:235], v[20:23], v[220:223]
    v_mfma_f32_16x16x32_bf16 v[236:239], a[236:239], v[20:23], v[236:239]
    v_mfma_f32_16x16x32_bf16 v[252:255], v[32:35], v[20:23], v[252:255]
    ds_read_b128 v[20:23], v8 offset:27648
    s_waitcnt lgkmcnt(3)
    v_mfma_f32_16x16x32_bf16 v[208:211], a[228:231], v[24:27], v[208:211]
    buffer_load_dwordx4 a[80:83], v6, s[12:15], s64 offen offset:3072 sc1
    v_mfma_f32_16x16x32_bf16 v[224:227], a[232:235], v[24:27], v[224:227]
    v_mfma_f32_16x16x32_bf16 v[240:243], a[236:239], v[24:27], v[240:243]
    ds_read_b128 v[24:27], v9 offset:3072
    ds_read_b128 v[32:35], v10 offset:3072
    s_waitcnt lgkmcnt(4)
    v_mfma_f32_16x16x32_bf16 v[212:215], a[228:231], v[28:31], v[212:215]
    v_mfma_f32_16x16x32_bf16 v[228:231], a[232:235], v[28:31], v[228:231]
    s_add_u32 s28, s28, 4096
    s_add_u32 m0, s74, 49152
    s_nop 0
    buffer_load_dwordx4 v1, s[12:15], s28 offen sc1 lds
    v_mfma_f32_16x16x32_bf16 v[244:247], a[236:239], v[28:31], v[244:247]
    ds_read_b128 v[28:31], v9 offset:27648
    s_waitcnt lgkmcnt(4)
    v_mfma_f32_16x16x32_bf16 v[144:147], a[56:59], v[16:19], v[144:147]
    v_mfma_f32_16x16x32_bf16 v[160:163], a[88:91], v[16:19], v[160:163]
    buffer_load_dwordx4 v1, s[12:15], s28 offen offset:1024 sc1 lds
    v_mfma_f32_16x16x32_bf16 v[176:179], a[96:99], v[16:19], v[176:179]
    s_waitcnt lgkmcnt(1)
    v_mfma_f32_16x16x32_bf16 v[192:195], v[32:35], v[16:19], v[192:195]
    ds_read_b128 v[16:19], v8 offset:15360
    v_mfma_f32_16x16x32_bf16 v[148:151], a[56:59], v[20:23], v[148:151]
    v_mfma_f32_16x16x32_bf16 v[164:167], a[88:91], v[20:23], v[164:167]
    buffer_load_dwordx4 v1, s[12:15], s28 offen offset:2048 sc1 lds
    v_mfma_f32_16x16x32_bf16 v[180:183], a[96:99], v[20:23], v[180:183]
    v_mfma_f32_16x16x32_bf16 v[196:199], v[32:35], v[20:23], v[196:199]
    ds_read_b128 v[20:23], v8 offset:39936
    v_mfma_f32_16x16x32_bf16 v[152:155], a[56:59], v[24:27], v[152:155]
    v_mfma_f32_16x16x32_bf16 v[168:171], a[88:91], v[24:27], v[168:171]
    v_mfma_f32_16x16x32_bf16 v[184:187], a[96:99], v[24:27], v[184:187]
    ds_read_b128 v[24:27], v9 offset:15360
    s_waitcnt lgkmcnt(3)
    v_mfma_f32_16x16x32_bf16 v[156:159], a[56:59], v[28:31], v[156:159]
    v_mfma_f32_16x16x32_bf16 v[172:175], a[88:91], v[28:31], v[172:175]
    v_mfma_f32_16x16x32_bf16 v[188:191], a[96:99], v[28:31], v[188:191]
    ds_read_b128 v[28:31], v9 offset:39936
    s_waitcnt vmcnt(20)
    s_barrier
    s_waitcnt lgkmcnt(3)
    v_mfma_f32_16x16x32_bf16 v[200:203], a[56:59], v[16:19], v[200:203]
    v_mfma_f32_16x16x32_bf16 v[216:219], a[88:91], v[16:19], v[216:219]
    v_mfma_f32_16x16x32_bf16 v[232:235], a[96:99], v[16:19], v[232:235]
    v_mfma_f32_16x16x32_bf16 v[248:251], v[32:35], v[16:19], v[248:251]
    ds_read_b128 v[16:19], v8 offset:4096
    s_waitcnt lgkmcnt(3)
    v_mfma_f32_16x16x32_bf16 v[204:207], a[56:59], v[20:23], v[204:207]
    v_mfma_f32_16x16x32_bf16 v[220:223], a[88:91], v[20:23], v[220:223]
    v_mfma_f32_16x16x32_bf16 v[236:239], a[96:99], v[20:23], v[236:239]
    v_mfma_f32_16x16x32_bf16 v[252:255], v[32:35], v[20:23], v[252:255]
    ds_read_b128 v[20:23], v8 offset:28672
    s_waitcnt lgkmcnt(3)
    v_mfma_f32_16x16x32_bf16 v[208:211], a[56:59], v[24:27], v[208:211]
    v_mfma_f32_16x16x32_bf16 v[224:227], a[88:91], v[24:27], v[224:227]
    v_mfma_f32_16x16x32_bf16 v[240:243], a[96:99], v[24:27], v[240:243]
    ds_read_b128 v[24:27], v9 offset:4096
    ds_read_b128 v[32:35], v10 offset:4096
    s_waitcnt lgkmcnt(4)
    v_mfma_f32_16x16x32_bf16 v[212:215], a[56:59], v[28:31], v[212:215]
    s_add_u32 s0, s0, 4096
    s_add_u32 m0, s74, 61440
    s_nop 0
    buffer_load_dwordx4 v1, s[12:15], s0 offen sc1 lds
    v_mfma_f32_16x16x32_bf16 v[228:231], a[88:91], v[28:31], v[228:231]
    v_mfma_f32_16x16x32_bf16 v[244:247], a[96:99], v[28:31], v[244:247]
    ds_read_b128 v[28:31], v9 offset:28672
    s_waitcnt vmcnt(19) lgkmcnt(4)
    v_mfma_f32_16x16x32_bf16 v[144:147], a[64:67], v[16:19], v[144:147]
    v_mfma_f32_16x16x32_bf16 v[160:163], a[104:107], v[16:19], v[160:163]
    s_add_u32 s64, s64, 4096
    buffer_load_dwordx4 a[164:167], v1, s[12:15], s64 offen sc1
    v_mfma_f32_16x16x32_bf16 v[176:179], a[108:111], v[16:19], v[176:179]
    s_waitcnt lgkmcnt(1)
    v_mfma_f32_16x16x32_bf16 v[192:195], v[32:35], v[16:19], v[192:195]
    ds_read_b128 v[16:19], v8 offset:16384
    v_mfma_f32_16x16x32_bf16 v[148:151], a[64:67], v[20:23], v[148:151]
    v_mfma_f32_16x16x32_bf16 v[164:167], a[104:107], v[20:23], v[164:167]
    v_mfma_f32_16x16x32_bf16 v[180:183], a[108:111], v[20:23], v[180:183]
    buffer_load_dwordx4 a[168:171], v5, s[12:15], s64 offen sc1
    v_mfma_f32_16x16x32_bf16 v[196:199], v[32:35], v[20:23], v[196:199]
    ds_read_b128 v[20:23], v8 offset:40960
    v_mfma_f32_16x16x32_bf16 v[152:155], a[64:67], v[24:27], v[152:155]
    v_mfma_f32_16x16x32_bf16 v[168:171], a[104:107], v[24:27], v[168:171]
    v_mfma_f32_16x16x32_bf16 v[184:187], a[108:111], v[24:27], v[184:187]
    ds_read_b128 v[24:27], v9 offset:16384
    s_waitcnt lgkmcnt(3)
    v_mfma_f32_16x16x32_bf16 v[156:159], a[64:67], v[28:31], v[156:159]
    buffer_load_dwordx4 a[172:175], v6, s[12:15], s64 offen sc1
    v_mfma_f32_16x16x32_bf16 v[172:175], a[104:107], v[28:31], v[172:175]
    v_mfma_f32_16x16x32_bf16 v[188:191], a[108:111], v[28:31], v[188:191]
    ds_read_b128 v[28:31], v9 offset:40960
    s_waitcnt lgkmcnt(3)
    v_mfma_f32_16x16x32_bf16 v[200:203], a[64:67], v[16:19], v[200:203]
    buffer_load_dwordx4 a[176:179], v1, s[12:15], s64 offen offset:1024 sc1
    v_mfma_f32_16x16x32_bf16 v[216:219], a[104:107], v[16:19], v[216:219]
    v_mfma_f32_16x16x32_bf16 v[232:235], a[108:111], v[16:19], v[232:235]
    v_mfma_f32_16x16x32_bf16 v[248:251], v[32:35], v[16:19], v[248:251]
    ds_read_b128 v[16:19], v8 offset:5120
    s_waitcnt lgkmcnt(3)
    v_mfma_f32_16x16x32_bf16 v[204:207], a[64:67], v[20:23], v[204:207]
    v_mfma_f32_16x16x32_bf16 v[220:223], a[104:107], v[20:23], v[220:223]
    buffer_load_dwordx4 a[180:183], v5, s[12:15], s64 offen offset:1024 sc1
    v_mfma_f32_16x16x32_bf16 v[236:239], a[108:111], v[20:23], v[236:239]
    v_mfma_f32_16x16x32_bf16 v[252:255], v[32:35], v[20:23], v[252:255]
    ds_read_b128 v[20:23], v8 offset:29696
    s_waitcnt lgkmcnt(3)
    v_mfma_f32_16x16x32_bf16 v[208:211], a[64:67], v[24:27], v[208:211]
    v_mfma_f32_16x16x32_bf16 v[224:227], a[104:107], v[24:27], v[224:227]
    buffer_load_dwordx4 a[184:187], v6, s[12:15], s64 offen offset:1024 sc1
    v_mfma_f32_16x16x32_bf16 v[240:243], a[108:111], v[24:27], v[240:243]
    ds_read_b128 v[24:27], v9 offset:5120
    ds_read_b128 v[32:35], v10 offset:5120
    s_waitcnt lgkmcnt(4)
    v_mfma_f32_16x16x32_bf16 v[212:215], a[64:67], v[28:31], v[212:215]
    v_mfma_f32_16x16x32_bf16 v[228:231], a[104:107], v[28:31], v[228:231]
    v_mfma_f32_16x16x32_bf16 v[244:247], a[108:111], v[28:31], v[244:247]
    ds_read_b128 v[28:31], v9 offset:29696
    s_waitcnt vmcnt(21) lgkmcnt(4)
    v_mfma_f32_16x16x32_bf16 v[144:147], a[112:115], v[16:19], v[144:147]
    s_add_u32 m0, s74, 49152
    s_nop 0
    buffer_load_dwordx4 v1, s[12:15], s28 offen offset:3072 sc1 lds
    v_mfma_f32_16x16x32_bf16 v[160:163], a[116:119], v[16:19], v[160:163]
    v_mfma_f32_16x16x32_bf16 v[176:179], a[72:75], v[16:19], v[176:179]
    s_add_u32 s28, s28, 4096
    s_add_u32 m0, s74, 40960
    s_nop 0
    buffer_load_dwordx4 v1, s[12:15], s28 offen sc1 lds
    s_waitcnt lgkmcnt(1)
    v_mfma_f32_16x16x32_bf16 v[192:195], v[32:35], v[16:19], v[192:195]
    ds_read_b128 v[16:19], v8 offset:17408
    v_mfma_f32_16x16x32_bf16 v[148:151], a[112:115], v[20:23], v[148:151]
    v_mfma_f32_16x16x32_bf16 v[164:167], a[116:119], v[20:23], v[164:167]
    v_mfma_f32_16x16x32_bf16 v[180:183], a[72:75], v[20:23], v[180:183]
    buffer_load_dwordx4 v1, s[12:15], s28 offen offset:1024 sc1 lds
    v_mfma_f32_16x16x32_bf16 v[196:199], v[32:35], v[20:23], v[196:199]
    ds_read_b128 v[20:23], v8 offset:41984
    v_mfma_f32_16x16x32_bf16 v[152:155], a[112:115], v[24:27], v[152:155]
    v_mfma_f32_16x16x32_bf16 v[168:171], a[116:119], v[24:27], v[168:171]
    buffer_load_dwordx4 v1, s[12:15], s28 offen offset:2048 sc1 lds
    v_mfma_f32_16x16x32_bf16 v[184:187], a[72:75], v[24:27], v[184:187]
    ds_read_b128 v[24:27], v9 offset:17408
    s_waitcnt lgkmcnt(3)
    v_mfma_f32_16x16x32_bf16 v[156:159], a[112:115], v[28:31], v[156:159]
    v_mfma_f32_16x16x32_bf16 v[172:175], a[116:119], v[28:31], v[172:175]
    v_mfma_f32_16x16x32_bf16 v[188:191], a[72:75], v[28:31], v[188:191]
    ds_read_b128 v[28:31], v9 offset:41984
    s_waitcnt vmcnt(21)
    s_barrier
    s_waitcnt lgkmcnt(3)
    v_mfma_f32_16x16x32_bf16 v[200:203], a[112:115], v[16:19], v[200:203]
    buffer_load_dwordx4 a[188:191], v1, s[12:15], s64 offen offset:2048 sc1
    v_mfma_f32_16x16x32_bf16 v[216:219], a[116:119], v[16:19], v[216:219]
    v_mfma_f32_16x16x32_bf16 v[232:235], a[72:75], v[16:19], v[232:235]
    v_mfma_f32_16x16x32_bf16 v[248:251], v[32:35], v[16:19], v[248:251]
    ds_read_b128 v[16:19], v8 offset:6144
    s_waitcnt lgkmcnt(3)
    v_mfma_f32_16x16x32_bf16 v[204:207], a[112:115], v[20:23], v[204:207]
    buffer_load_dwordx4 a[192:195], v5, s[12:15], s64 offen offset:2048 sc1
    v_mfma_f32_16x16x32_bf16 v[220:223], a[116:119], v[20:23], v[220:223]
    v_mfma_f32_16x16x32_bf16 v[236:239], a[72:75], v[20:23], v[236:239]
    v_mfma_f32_16x16x32_bf16 v[252:255], v[32:35], v[20:23], v[252:255]
    ds_read_b128 v[20:23], v8 offset:30720
    s_waitcnt lgkmcnt(3)
    v_mfma_f32_16x16x32_bf16 v[208:211], a[112:115], v[24:27], v[208:211]
    v_mfma_f32_16x16x32_bf16 v[224:227], a[116:119], v[24:27], v[224:227]
    buffer_load_dwordx4 a[196:199], v6, s[12:15], s64 offen offset:2048 sc1
    v_mfma_f32_16x16x32_bf16 v[240:243], a[72:75], v[24:27], v[240:243]
    ds_read_b128 v[24:27], v9 offset:6144
    ds_read_b128 v[32:35], v10 offset:6144
    s_waitcnt lgkmcnt(4)
    v_mfma_f32_16x16x32_bf16 v[212:215], a[112:115], v[28:31], v[212:215]
    v_mfma_f32_16x16x32_bf16 v[228:231], a[116:119], v[28:31], v[228:231]
    v_mfma_f32_16x16x32_bf16 v[244:247], a[72:75], v[28:31], v[244:247]
    ds_read_b128 v[28:31], v9 offset:30720
    s_waitcnt vmcnt(20) lgkmcnt(4)
    v_mfma_f32_16x16x32_bf16 v[144:147], a[76:79], v[16:19], v[144:147]
    buffer_load_dwordx4 a[200:203], v1, s[12:15], s64 offen offset:3072 sc1
    v_mfma_f32_16x16x32_bf16 v[160:163], a[120:123], v[16:19], v[160:163]
    v_mfma_f32_16x16x32_bf16 v[176:179], a[124:127], v[16:19], v[176:179]
    s_waitcnt lgkmcnt(1)
    v_mfma_f32_16x16x32_bf16 v[192:195], v[32:35], v[16:19], v[192:195]
    ds_read_b128 v[16:19], v8 offset:18432
    v_mfma_f32_16x16x32_bf16 v[148:151], a[76:79], v[20:23], v[148:151]
    buffer_load_dwordx4 a[84:87], v5, s[12:15], s64 offen offset:3072 sc1
    v_mfma_f32_16x16x32_bf16 v[164:167], a[120:123], v[20:23], v[164:167]
    v_mfma_f32_16x16x32_bf16 v[180:183], a[124:127], v[20:23], v[180:183]
    v_mfma_f32_16x16x32_bf16 v[196:199], v[32:35], v[20:23], v[196:199]
    ds_read_b128 v[20:23], v8 offset:43008
    v_mfma_f32_16x16x32_bf16 v[152:155], a[76:79], v[24:27], v[152:155]
    buffer_load_dwordx4 a[136:139], v6, s[12:15], s64 offen offset:3072 sc1
    v_mfma_f32_16x16x32_bf16 v[168:171], a[120:123], v[24:27], v[168:171]
    v_mfma_f32_16x16x32_bf16 v[184:187], a[124:127], v[24:27], v[184:187]
    ds_read_b128 v[24:27], v9 offset:18432
    s_waitcnt lgkmcnt(3)
    v_mfma_f32_16x16x32_bf16 v[156:159], a[76:79], v[28:31], v[156:159]
    s_add_u32 s64, s64, 4096
    buffer_load_dwordx4 a[140:143], v1, s[12:15], s64 offen sc1
    v_mfma_f32_16x16x32_bf16 v[172:175], a[120:123], v[28:31], v[172:175]
    v_mfma_f32_16x16x32_bf16 v[188:191], a[124:127], v[28:31], v[188:191]
    ds_read_b128 v[28:31], v9 offset:43008
    s_waitcnt lgkmcnt(3)
    v_mfma_f32_16x16x32_bf16 v[200:203], a[76:79], v[16:19], v[200:203]
    v_mfma_f32_16x16x32_bf16 v[216:219], a[120:123], v[16:19], v[216:219]
    buffer_load_dwordx4 a[144:147], v5, s[12:15], s64 offen sc1
    v_mfma_f32_16x16x32_bf16 v[232:235], a[124:127], v[16:19], v[232:235]
    v_mfma_f32_16x16x32_bf16 v[248:251], v[32:35], v[16:19], v[248:251]
    ds_read_b128 v[16:19], v8 offset:7168
    s_waitcnt lgkmcnt(3)
    v_mfma_f32_16x16x32_bf16 v[204:207], a[76:79], v[20:23], v[204:207]
    v_mfma_f32_16x16x32_bf16 v[220:223], a[120:123], v[20:23], v[220:223]
    buffer_load_dwordx4 a[148:151], v6, s[12:15], s64 offen sc1
    v_mfma_f32_16x16x32_bf16 v[236:239], a[124:127], v[20:23], v[236:239]
    v_mfma_f32_16x16x32_bf16 v[252:255], v[32:35], v[20:23], v[252:255]
    ds_read_b128 v[20:23], v8 offset:31744
    s_waitcnt lgkmcnt(3)
    v_mfma_f32_16x16x32_bf16 v[208:211], a[76:79], v[24:27], v[208:211]
    buffer_load_dwordx4 a[152:155], v1, s[12:15], s64 offen offset:1024 sc1
    v_mfma_f32_16x16x32_bf16 v[224:227], a[120:123], v[24:27], v[224:227]
    v_mfma_f32_16x16x32_bf16 v[240:243], a[124:127], v[24:27], v[240:243]
    ds_read_b128 v[24:27], v9 offset:7168
    ds_read_b128 v[32:35], v10 offset:7168
    s_waitcnt lgkmcnt(4)
    v_mfma_f32_16x16x32_bf16 v[212:215], a[76:79], v[28:31], v[212:215]
    v_mfma_f32_16x16x32_bf16 v[228:231], a[120:123], v[28:31], v[228:231]
    v_mfma_f32_16x16x32_bf16 v[244:247], a[124:127], v[28:31], v[244:247]
    ds_read_b128 v[28:31], v9 offset:31744
    s_waitcnt vmcnt(24) lgkmcnt(4)
    v_mfma_f32_16x16x32_bf16 v[144:147], a[128:131], v[16:19], v[144:147]
    buffer_load_dwordx4 a[156:159], v5, s[12:15], s64 offen offset:1024 sc1
    v_mfma_f32_16x16x32_bf16 v[160:163], a[132:135], v[16:19], v[160:163]
    v_mfma_f32_16x16x32_bf16 v[176:179], a[80:83], v[16:19], v[176:179]
    s_waitcnt lgkmcnt(1)
    v_mfma_f32_16x16x32_bf16 v[192:195], v[32:35], v[16:19], v[192:195]
    ds_read_b128 v[16:19], v8 offset:19456
    v_mfma_f32_16x16x32_bf16 v[148:151], a[128:131], v[20:23], v[148:151]
    buffer_load_dwordx4 a[160:163], v6, s[12:15], s64 offen offset:1024 sc1
    v_mfma_f32_16x16x32_bf16 v[164:167], a[132:135], v[20:23], v[164:167]
    v_mfma_f32_16x16x32_bf16 v[180:183], a[80:83], v[20:23], v[180:183]
    v_mfma_f32_16x16x32_bf16 v[196:199], v[32:35], v[20:23], v[196:199]
    ds_read_b128 v[20:23], v8 offset:44032
    v_mfma_f32_16x16x32_bf16 v[152:155], a[128:131], v[24:27], v[152:155]
    buffer_load_dwordx4 v1, s[12:15], s28 offen offset:3072 sc1 lds
    v_mfma_f32_16x16x32_bf16 v[168:171], a[132:135], v[24:27], v[168:171]
    v_mfma_f32_16x16x32_bf16 v[184:187], a[80:83], v[24:27], v[184:187]
    ds_read_b128 v[24:27], v9 offset:19456
    s_waitcnt lgkmcnt(3)
    v_mfma_f32_16x16x32_bf16 v[156:159], a[128:131], v[28:31], v[156:159]
    v_mfma_f32_16x16x32_bf16 v[172:175], a[132:135], v[28:31], v[172:175]
    s_add_u32 s28, s28, 4096
    s_add_u32 m0, s74, 45056
    s_nop 0
    buffer_load_dwordx4 v1, s[12:15], s28 offen sc1 lds
    v_mfma_f32_16x16x32_bf16 v[188:191], a[80:83], v[28:31], v[188:191]
    ds_read_b128 v[28:31], v9 offset:44032
    s_waitcnt vmcnt(24)
    s_barrier
    s_waitcnt lgkmcnt(3)
    v_mfma_f32_16x16x32_bf16 v[200:203], a[128:131], v[16:19], v[200:203]
    v_mfma_f32_16x16x32_bf16 v[216:219], a[132:135], v[16:19], v[216:219]
    v_mfma_f32_16x16x32_bf16 v[232:235], a[80:83], v[16:19], v[232:235]
    buffer_load_dwordx4 v1, s[12:15], s28 offen offset:1024 sc1 lds
    v_mfma_f32_16x16x32_bf16 v[248:251], v[32:35], v[16:19], v[248:251]
    ds_read_b128 v[16:19], v8 offset:8192
    s_waitcnt lgkmcnt(3)
    v_mfma_f32_16x16x32_bf16 v[204:207], a[128:131], v[20:23], v[204:207]
    v_mfma_f32_16x16x32_bf16 v[220:223], a[132:135], v[20:23], v[220:223]
    v_mfma_f32_16x16x32_bf16 v[236:239], a[80:83], v[20:23], v[236:239]
    v_mfma_f32_16x16x32_bf16 v[252:255], v[32:35], v[20:23], v[252:255]
    ds_read_b128 v[20:23], v8 offset:32768
    s_waitcnt lgkmcnt(3)
    v_mfma_f32_16x16x32_bf16 v[208:211], a[128:131], v[24:27], v[208:211]
    buffer_load_dwordx4 v1, s[12:15], s28 offen offset:2048 sc1 lds
    v_mfma_f32_16x16x32_bf16 v[224:227], a[132:135], v[24:27], v[224:227]
    v_mfma_f32_16x16x32_bf16 v[240:243], a[80:83], v[24:27], v[240:243]
    ds_read_b128 v[24:27], v9 offset:8192
    ds_read_b128 v[32:35], v10 offset:8192
    s_waitcnt lgkmcnt(4)
    v_mfma_f32_16x16x32_bf16 v[212:215], a[128:131], v[28:31], v[212:215]
    buffer_load_dwordx4 a[0:3], v1, s[12:15], s64 offen offset:2048 sc1
    v_mfma_f32_16x16x32_bf16 v[228:231], a[132:135], v[28:31], v[228:231]
    v_mfma_f32_16x16x32_bf16 v[244:247], a[80:83], v[28:31], v[244:247]
    ds_read_b128 v[28:31], v9 offset:32768
    s_waitcnt vmcnt(24) lgkmcnt(4)
    v_mfma_f32_16x16x32_bf16 v[144:147], a[164:167], v[16:19], v[144:147]
    v_mfma_f32_16x16x32_bf16 v[160:163], a[168:171], v[16:19], v[160:163]
    buffer_load_dwordx4 a[4:7], v5, s[12:15], s64 offen offset:2048 sc1
    v_mfma_f32_16x16x32_bf16 v[176:179], a[172:175], v[16:19], v[176:179]
    s_waitcnt lgkmcnt(1)
    v_mfma_f32_16x16x32_bf16 v[192:195], v[32:35], v[16:19], v[192:195]
    ds_read_b128 v[16:19], v8 offset:20480
    v_mfma_f32_16x16x32_bf16 v[148:151], a[164:167], v[20:23], v[148:151]
    v_mfma_f32_16x16x32_bf16 v[164:167], a[168:171], v[20:23], v[164:167]
    v_mfma_f32_16x16x32_bf16 v[180:183], a[172:175], v[20:23], v[180:183]
    buffer_load_dwordx4 a[8:11], v6, s[12:15], s64 offen offset:2048 sc1
    v_mfma_f32_16x16x32_bf16 v[196:199], v[32:35], v[20:23], v[196:199]
    ds_read_b128 v[20:23], v8 offset:45056
    v_mfma_f32_16x16x32_bf16 v[152:155], a[164:167], v[24:27], v[152:155]
    v_mfma_f32_16x16x32_bf16 v[168:171], a[168:171], v[24:27], v[168:171]
    v_mfma_f32_16x16x32_bf16 v[184:187], a[172:175], v[24:27], v[184:187]
    ds_read_b128 v[24:27], v9 offset:20480
    s_waitcnt lgkmcnt(3)
    v_mfma_f32_16x16x32_bf16 v[156:159], a[164:167], v[28:31], v[156:159]
    buffer_load_dwordx4 a[12:15], v1, s[12:15], s64 offen offset:3072 sc1
    v_mfma_f32_16x16x32_bf16 v[172:175], a[168:171], v[28:31], v[172:175]
    v_mfma_f32_16x16x32_bf16 v[188:191], a[172:175], v[28:31], v[188:191]
    ds_read_b128 v[28:31], v9 offset:45056
    s_waitcnt lgkmcnt(3)
    v_mfma_f32_16x16x32_bf16 v[200:203], a[164:167], v[16:19], v[200:203]
    buffer_load_dwordx4 a[16:19], v5, s[12:15], s64 offen offset:3072 sc1
    v_mfma_f32_16x16x32_bf16 v[216:219], a[168:171], v[16:19], v[216:219]
    v_mfma_f32_16x16x32_bf16 v[232:235], a[172:175], v[16:19], v[232:235]
    v_mfma_f32_16x16x32_bf16 v[248:251], v[32:35], v[16:19], v[248:251]
    ds_read_b128 v[16:19], v8 offset:9216
    s_waitcnt lgkmcnt(3)
    v_mfma_f32_16x16x32_bf16 v[204:207], a[164:167], v[20:23], v[204:207]
    v_mfma_f32_16x16x32_bf16 v[220:223], a[168:171], v[20:23], v[220:223]
    buffer_load_dwordx4 v[56:59], v6, s[12:15], s64 offen offset:3072 sc1
    v_mfma_f32_16x16x32_bf16 v[236:239], a[172:175], v[20:23], v[236:239]
    v_mfma_f32_16x16x32_bf16 v[252:255], v[32:35], v[20:23], v[252:255]
    ds_read_b128 v[20:23], v8 offset:33792
    s_waitcnt lgkmcnt(3)
    v_mfma_f32_16x16x32_bf16 v[208:211], a[164:167], v[24:27], v[208:211]
    v_mfma_f32_16x16x32_bf16 v[224:227], a[168:171], v[24:27], v[224:227]
    s_add_u32 s64, s64, 4096
    buffer_load_dwordx4 v[60:63], v1, s[12:15], s64 offen sc1
    v_mfma_f32_16x16x32_bf16 v[240:243], a[172:175], v[24:27], v[240:243]
    ds_read_b128 v[24:27], v9 offset:9216
    ds_read_b128 v[32:35], v10 offset:9216
    s_waitcnt lgkmcnt(4)
    v_mfma_f32_16x16x32_bf16 v[212:215], a[164:167], v[28:31], v[212:215]
    v_mfma_f32_16x16x32_bf16 v[228:231], a[168:171], v[28:31], v[228:231]
    buffer_load_dwordx4 v[64:67], v5, s[12:15], s64 offen sc1
    v_mfma_f32_16x16x32_bf16 v[244:247], a[172:175], v[28:31], v[244:247]
    ds_read_b128 v[28:31], v9 offset:33792
    s_waitcnt vmcnt(28) lgkmcnt(4)
    v_mfma_f32_16x16x32_bf16 v[144:147], a[176:179], v[16:19], v[144:147]
    v_mfma_f32_16x16x32_bf16 v[160:163], a[180:183], v[16:19], v[160:163]
    v_mfma_f32_16x16x32_bf16 v[176:179], a[184:187], v[16:19], v[176:179]
    buffer_load_dwordx4 v[68:71], v6, s[12:15], s64 offen sc1
    s_waitcnt lgkmcnt(1)
    v_mfma_f32_16x16x32_bf16 v[192:195], v[32:35], v[16:19], v[192:195]
    ds_read_b128 v[16:19], v8 offset:10240
    v_mfma_f32_16x16x32_bf16 v[148:151], a[176:179], v[20:23], v[148:151]
    v_mfma_f32_16x16x32_bf16 v[164:167], a[180:183], v[20:23], v[164:167]
    v_mfma_f32_16x16x32_bf16 v[180:183], a[184:187], v[20:23], v[180:183]
    buffer_load_dwordx4 v[72:75], v1, s[12:15], s64 offen offset:1024 sc1
    v_mfma_f32_16x16x32_bf16 v[196:199], v[32:35], v[20:23], v[196:199]
    ds_read_b128 v[20:23], v8 offset:34816
    v_mfma_f32_16x16x32_bf16 v[152:155], a[176:179], v[24:27], v[152:155]
    v_mfma_f32_16x16x32_bf16 v[168:171], a[180:183], v[24:27], v[168:171]
    v_mfma_f32_16x16x32_bf16 v[184:187], a[184:187], v[24:27], v[184:187]
    ds_read_b128 v[24:27], v9 offset:10240
    ds_read_b128 v[32:35], v10 offset:10240
    s_waitcnt lgkmcnt(4)
    v_mfma_f32_16x16x32_bf16 v[156:159], a[176:179], v[28:31], v[156:159]
    buffer_load_dwordx4 v[76:79], v5, s[12:15], s64 offen offset:1024 sc1
    v_mfma_f32_16x16x32_bf16 v[172:175], a[180:183], v[28:31], v[172:175]
    v_mfma_f32_16x16x32_bf16 v[188:191], a[184:187], v[28:31], v[188:191]
    ds_read_b128 v[28:31], v9 offset:34816
    s_waitcnt vmcnt(27)
    s_barrier
    s_waitcnt vmcnt(24) lgkmcnt(4)
    v_mfma_f32_16x16x32_bf16 v[144:147], a[188:191], v[16:19], v[144:147]
    buffer_load_dwordx4 v[80:83], v6, s[12:15], s64 offen offset:1024 sc1
    v_mfma_f32_16x16x32_bf16 v[160:163], a[192:195], v[16:19], v[160:163]
    v_mfma_f32_16x16x32_bf16 v[176:179], a[196:199], v[16:19], v[176:179]
    s_waitcnt lgkmcnt(1)
    v_mfma_f32_16x16x32_bf16 v[192:195], v[32:35], v[16:19], v[192:195]
    ds_read_b128 v[16:19], v8 offset:11264
    v_mfma_f32_16x16x32_bf16 v[148:151], a[188:191], v[20:23], v[148:151]
    v_mfma_f32_16x16x32_bf16 v[164:167], a[192:195], v[20:23], v[164:167]
    buffer_load_dwordx4 v1, s[12:15], s28 offen offset:3072 sc1 lds
    v_mfma_f32_16x16x32_bf16 v[180:183], a[196:199], v[20:23], v[180:183]
    v_mfma_f32_16x16x32_bf16 v[196:199], v[32:35], v[20:23], v[196:199]
    ds_read_b128 v[20:23], v8 offset:35840
    v_mfma_f32_16x16x32_bf16 v[152:155], a[188:191], v[24:27], v[152:155]
    v_mfma_f32_16x16x32_bf16 v[168:171], a[192:195], v[24:27], v[168:171]
    s_add_u32 m0, s74, 61440
    s_nop 0
    buffer_load_dwordx4 v1, s[12:15], s0 offen offset:1024 sc1 lds
    v_mfma_f32_16x16x32_bf16 v[184:187], a[196:199], v[24:27], v[184:187]
    ds_read_b128 v[24:27], v9 offset:11264
    ds_read_b128 v[32:35], v10 offset:11264
    s_waitcnt lgkmcnt(4)
    v_mfma_f32_16x16x32_bf16 v[156:159], a[188:191], v[28:31], v[156:159]
    v_mfma_f32_16x16x32_bf16 v[172:175], a[192:195], v[28:31], v[172:175]
    v_mfma_f32_16x16x32_bf16 v[188:191], a[196:199], v[28:31], v[188:191]
    ds_read_b128 v[28:31], v9 offset:35840
    s_waitcnt vmcnt(24) lgkmcnt(4)
    v_mfma_f32_16x16x32_bf16 v[144:147], a[200:203], v[16:19], v[144:147]
    buffer_load_dwordx4 v1, s[12:15], s0 offen offset:2048 sc1 lds
    v_mfma_f32_16x16x32_bf16 v[160:163], a[84:87], v[16:19], v[160:163]
    v_mfma_f32_16x16x32_bf16 v[176:179], a[136:139], v[16:19], v[176:179]
    s_waitcnt lgkmcnt(1)
    v_mfma_f32_16x16x32_bf16 v[192:195], v[32:35], v[16:19], v[192:195]
    ds_read_b128 v[16:19], v8 offset:0
    v_mfma_f32_16x16x32_bf16 v[148:151], a[200:203], v[20:23], v[148:151]
    buffer_load_dwordx4 v1, s[12:15], s0 offen offset:3072 sc1 lds
    v_mfma_f32_16x16x32_bf16 v[164:167], a[84:87], v[20:23], v[164:167]
    v_mfma_f32_16x16x32_bf16 v[180:183], a[136:139], v[20:23], v[180:183]
    v_mfma_f32_16x16x32_bf16 v[196:199], v[32:35], v[20:23], v[196:199]
    ds_read_b128 v[20:23], v8 offset:24576
    v_mfma_f32_16x16x32_bf16 v[152:155], a[200:203], v[24:27], v[152:155]
    buffer_load_dwordx4 v[84:87], v1, s[12:15], s64 offen offset:2048 sc1
    v_mfma_f32_16x16x32_bf16 v[168:171], a[84:87], v[24:27], v[168:171]
    v_mfma_f32_16x16x32_bf16 v[184:187], a[136:139], v[24:27], v[184:187]
    ds_read_b128 v[24:27], v9 offset:0
    ds_read_b128 v[32:35], v10 offset:12288
    s_waitcnt lgkmcnt(4)
    v_mfma_f32_16x16x32_bf16 v[156:159], a[200:203], v[28:31], v[156:159]
    v_mfma_f32_16x16x32_bf16 v[172:175], a[84:87], v[28:31], v[172:175]
    v_mfma_f32_16x16x32_bf16 v[188:191], a[136:139], v[28:31], v[188:191]
    ds_read_b128 v[28:31], v9 offset:24576
    s_waitcnt vmcnt(24) lgkmcnt(4)
    v_mfma_f32_16x16x32_bf16 v[144:147], a[140:143], v[16:19], v[144:147]
    buffer_load_dwordx4 v[88:91], v5, s[12:15], s64 offen offset:2048 sc1
    v_mfma_f32_16x16x32_bf16 v[160:163], a[144:147], v[16:19], v[160:163]
    v_mfma_f32_16x16x32_bf16 v[176:179], a[148:151], v[16:19], v[176:179]
    s_waitcnt lgkmcnt(1)
    v_mfma_f32_16x16x32_bf16 v[192:195], v[32:35], v[16:19], v[192:195]
    ds_read_b128 v[16:19], v8 offset:1024
    v_mfma_f32_16x16x32_bf16 v[148:151], a[140:143], v[20:23], v[148:151]
    buffer_load_dwordx4 v[92:95], v6, s[12:15], s64 offen offset:2048 sc1
    v_mfma_f32_16x16x32_bf16 v[164:167], a[144:147], v[20:23], v[164:167]
    v_mfma_f32_16x16x32_bf16 v[180:183], a[148:151], v[20:23], v[180:183]
    buffer_load_dwordx4 v[96:99], v1, s[12:15], s64 offen offset:3072 sc1
    v_mfma_f32_16x16x32_bf16 v[196:199], v[32:35], v[20:23], v[196:199]
    ds_read_b128 v[20:23], v8 offset:25600
    v_mfma_f32_16x16x32_bf16 v[152:155], a[140:143], v[24:27], v[152:155]
    v_mfma_f32_16x16x32_bf16 v[168:171], a[144:147], v[24:27], v[168:171]
    v_mfma_f32_16x16x32_bf16 v[184:187], a[148:151], v[24:27], v[184:187]
    ds_read_b128 v[24:27], v9 offset:1024
    ds_read_b128 v[32:35], v10 offset:13312
    s_waitcnt lgkmcnt(4)
    v_mfma_f32_16x16x32_bf16 v[156:159], a[140:143], v[28:31], v[156:159]
    buffer_load_dwordx4 v[100:103], v5, s[12:15], s64 offen offset:3072 sc1
    v_mfma_f32_16x16x32_bf16 v[172:175], a[144:147], v[28:31], v[172:175]
    v_mfma_f32_16x16x32_bf16 v[188:191], a[148:151], v[28:31], v[188:191]
    ds_read_b128 v[28:31], v9 offset:25600
    s_waitcnt vmcnt(25) lgkmcnt(4)
    v_mfma_f32_16x16x32_bf16 v[144:147], a[152:155], v[16:19], v[144:147]
    buffer_load_dwordx4 v[104:107], v6, s[12:15], s64 offen offset:3072 sc1
    v_mfma_f32_16x16x32_bf16 v[160:163], a[156:159], v[16:19], v[160:163]
    v_mfma_f32_16x16x32_bf16 v[176:179], a[160:163], v[16:19], v[176:179]
    s_waitcnt lgkmcnt(1)
    v_mfma_f32_16x16x32_bf16 v[192:195], v[32:35], v[16:19], v[192:195]
    ds_read_b128 v[16:19], v8 offset:2048
    v_mfma_f32_16x16x32_bf16 v[148:151], a[152:155], v[20:23], v[148:151]
    s_add_u32 s0, s0, 4096
    s_add_u32 m0, s74, 53248
    s_nop 0
    buffer_load_dwordx4 v1, s[12:15], s0 offen sc1 lds
    v_mfma_f32_16x16x32_bf16 v[164:167], a[156:159], v[20:23], v[164:167]
    v_mfma_f32_16x16x32_bf16 v[180:183], a[160:163], v[20:23], v[180:183]
    v_mfma_f32_16x16x32_bf16 v[196:199], v[32:35], v[20:23], v[196:199]
    ds_read_b128 v[20:23], v8 offset:26624
    v_mfma_f32_16x16x32_bf16 v[152:155], a[152:155], v[24:27], v[152:155]
    buffer_load_dwordx4 v1, s[12:15], s0 offen offset:1024 sc1 lds
    v_mfma_f32_16x16x32_bf16 v[168:171], a[156:159], v[24:27], v[168:171]
    v_mfma_f32_16x16x32_bf16 v[184:187], a[160:163], v[24:27], v[184:187]
    ds_read_b128 v[24:27], v9 offset:2048
    ds_read_b128 v[32:35], v10 offset:14336
    s_waitcnt lgkmcnt(4)
    v_mfma_f32_16x16x32_bf16 v[156:159], a[152:155], v[28:31], v[156:159]
    buffer_load_dwordx4 v1, s[12:15], s0 offen offset:2048 sc1 lds
    v_mfma_f32_16x16x32_bf16 v[172:175], a[156:159], v[28:31], v[172:175]
    v_mfma_f32_16x16x32_bf16 v[188:191], a[160:163], v[28:31], v[188:191]
    ds_read_b128 v[28:31], v9 offset:26624
    s_waitcnt vmcnt(25)
    s_barrier
    s_waitcnt vmcnt(22) lgkmcnt(4)
    v_mfma_f32_16x16x32_bf16 v[144:147], a[0:3], v[16:19], v[144:147]
    buffer_load_dwordx4 v1, s[12:15], s0 offen offset:3072 sc1 lds
    v_mfma_f32_16x16x32_bf16 v[160:163], a[4:7], v[16:19], v[160:163]
    v_mfma_f32_16x16x32_bf16 v[176:179], a[8:11], v[16:19], v[176:179]
    s_waitcnt lgkmcnt(1)
    v_mfma_f32_16x16x32_bf16 v[192:195], v[32:35], v[16:19], v[192:195]
    ds_read_b128 v[16:19], v8 offset:3072
    v_mfma_f32_16x16x32_bf16 v[148:151], a[0:3], v[20:23], v[148:151]
    s_add_u32 s0, s0, 4096
    s_add_u32 m0, s74, 57344
    s_nop 0
    buffer_load_dwordx4 v1, s[12:15], s0 offen sc1 lds
    v_mfma_f32_16x16x32_bf16 v[164:167], a[4:7], v[20:23], v[164:167]
    v_mfma_f32_16x16x32_bf16 v[180:183], a[8:11], v[20:23], v[180:183]
    v_mfma_f32_16x16x32_bf16 v[196:199], v[32:35], v[20:23], v[196:199]
    ds_read_b128 v[20:23], v8 offset:27648
    v_mfma_f32_16x16x32_bf16 v[152:155], a[0:3], v[24:27], v[152:155]
    buffer_load_dwordx4 v1, s[12:15], s0 offen offset:1024 sc1 lds
    v_mfma_f32_16x16x32_bf16 v[168:171], a[4:7], v[24:27], v[168:171]
    v_mfma_f32_16x16x32_bf16 v[184:187], a[8:11], v[24:27], v[184:187]
    ds_read_b128 v[24:27], v9 offset:3072
    ds_read_b128 v[32:35], v10 offset:15360
    s_waitcnt lgkmcnt(4)
    v_mfma_f32_16x16x32_bf16 v[156:159], a[0:3], v[28:31], v[156:159]
    buffer_load_dwordx4 v1, s[12:15], s0 offen offset:2048 sc1 lds
    v_mfma_f32_16x16x32_bf16 v[172:175], a[4:7], v[28:31], v[172:175]
    v_mfma_f32_16x16x32_bf16 v[188:191], a[8:11], v[28:31], v[188:191]
    ds_read_b128 v[28:31], v9 offset:27648
    s_waitcnt vmcnt(23) lgkmcnt(4)
    v_mfma_f32_16x16x32_bf16 v[144:147], a[12:15], v[16:19], v[144:147]
    v_mfma_f32_16x16x32_bf16 v[160:163], a[16:19], v[16:19], v[160:163]
    buffer_load_dwordx4 v1, s[12:15], s0 offen offset:3072 sc1 lds
    v_mfma_f32_16x16x32_bf16 v[176:179], v[56:59], v[16:19], v[176:179]
    s_waitcnt lgkmcnt(1)
    v_mfma_f32_16x16x32_bf16 v[192:195], v[32:35], v[16:19], v[192:195]
    ds_read_b128 v[16:19], v8 offset:4096
    v_mfma_f32_16x16x32_bf16 v[148:151], a[12:15], v[20:23], v[148:151]
    v_mfma_f32_16x16x32_bf16 v[164:167], a[16:19], v[20:23], v[164:167]
    buffer_load_dwordx4 v[108:111], v1, s[12:15], s65 offen offset:2048 sc1
    v_mfma_f32_16x16x32_bf16 v[180:183], v[56:59], v[20:23], v[180:183]
    v_mfma_f32_16x16x32_bf16 v[196:199], v[32:35], v[20:23], v[196:199]
    ds_read_b128 v[20:23], v8 offset:28672
    v_mfma_f32_16x16x32_bf16 v[152:155], a[12:15], v[24:27], v[152:155]
    buffer_load_dwordx4 v[112:115], v1, s[12:15], s65 offen offset:3072 sc1
    v_mfma_f32_16x16x32_bf16 v[168:171], a[16:19], v[24:27], v[168:171]
    v_mfma_f32_16x16x32_bf16 v[184:187], v[56:59], v[24:27], v[184:187]
    ds_read_b128 v[24:27], v9 offset:4096
    ds_read_b128 v[32:35], v10 offset:16384
    s_waitcnt lgkmcnt(4)
    v_mfma_f32_16x16x32_bf16 v[156:159], a[12:15], v[28:31], v[156:159]
    v_mfma_f32_16x16x32_bf16 v[172:175], a[16:19], v[28:31], v[172:175]
    s_add_u32 s65, s65, 4096
    buffer_load_dwordx4 v[116:119], v1, s[12:15], s65 offen sc1
    v_mfma_f32_16x16x32_bf16 v[188:191], v[56:59], v[28:31], v[188:191]
    ds_read_b128 v[28:31], v9 offset:28672
    s_waitcnt vmcnt(24) lgkmcnt(4)
    v_mfma_f32_16x16x32_bf16 v[144:147], v[60:63], v[16:19], v[144:147]
    v_mfma_f32_16x16x32_bf16 v[160:163], v[64:67], v[16:19], v[160:163]
    buffer_load_dwordx4 v[120:123], v1, s[12:15], s65 offen offset:1024 sc1
    v_mfma_f32_16x16x32_bf16 v[176:179], v[68:71], v[16:19], v[176:179]
    s_waitcnt lgkmcnt(1)
    v_mfma_f32_16x16x32_bf16 v[192:195], v[32:35], v[16:19], v[192:195]
    ds_read_b128 v[16:19], v8 offset:5120
    v_mfma_f32_16x16x32_bf16 v[148:151], v[60:63], v[20:23], v[148:151]
    buffer_load_dwordx4 v[124:127], v1, s[12:15], s65 offen offset:2048 sc1
    v_mfma_f32_16x16x32_bf16 v[164:167], v[64:67], v[20:23], v[164:167]
    v_mfma_f32_16x16x32_bf16 v[180:183], v[68:71], v[20:23], v[180:183]
    v_mfma_f32_16x16x32_bf16 v[196:199], v[32:35], v[20:23], v[196:199]
    ds_read_b128 v[20:23], v8 offset:29696
    v_mfma_f32_16x16x32_bf16 v[152:155], v[60:63], v[24:27], v[152:155]
    buffer_load_dwordx4 v[128:131], v1, s[12:15], s65 offen offset:3072 sc1
    v_mfma_f32_16x16x32_bf16 v[168:171], v[64:67], v[24:27], v[168:171]
    v_mfma_f32_16x16x32_bf16 v[184:187], v[68:71], v[24:27], v[184:187]
    ds_read_b128 v[24:27], v9 offset:5120
    ds_read_b128 v[32:35], v10 offset:17408
    s_waitcnt lgkmcnt(4)
    v_mfma_f32_16x16x32_bf16 v[156:159], v[60:63], v[28:31], v[156:159]
    s_add_u32 s65, s65, 4096
    buffer_load_dwordx4 v[132:135], v1, s[12:15], s65 offen sc1
    v_mfma_f32_16x16x32_bf16 v[172:175], v[64:67], v[28:31], v[172:175]
    v_mfma_f32_16x16x32_bf16 v[188:191], v[68:71], v[28:31], v[188:191]
    ds_read_b128 v[28:31], v9 offset:29696
    s_waitcnt vmcnt(25) lgkmcnt(4)
    v_mfma_f32_16x16x32_bf16 v[144:147], v[72:75], v[16:19], v[144:147]
    buffer_load_dwordx4 v[136:139], v1, s[12:15], s65 offen offset:1024 sc1
    v_mfma_f32_16x16x32_bf16 v[160:163], v[76:79], v[16:19], v[160:163]
    v_mfma_f32_16x16x32_bf16 v[176:179], v[80:83], v[16:19], v[176:179]
    s_waitcnt lgkmcnt(1)
    v_mfma_f32_16x16x32_bf16 v[192:195], v[32:35], v[16:19], v[192:195]
    ds_read_b128 v[16:19], v8 offset:6144
    v_mfma_f32_16x16x32_bf16 v[148:151], v[72:75], v[20:23], v[148:151]
    buffer_load_dwordx4 v[140:143], v1, s[12:15], s65 offen offset:2048 sc1
    v_mfma_f32_16x16x32_bf16 v[164:167], v[76:79], v[20:23], v[164:167]
    v_mfma_f32_16x16x32_bf16 v[180:183], v[80:83], v[20:23], v[180:183]
    v_mfma_f32_16x16x32_bf16 v[196:199], v[32:35], v[20:23], v[196:199]
    ds_read_b128 v[20:23], v8 offset:30720
    v_mfma_f32_16x16x32_bf16 v[152:155], v[72:75], v[24:27], v[152:155]
    buffer_load_dwordx4 a[204:207], v1, s[12:15], s65 offen offset:3072 sc1
    v_mfma_f32_16x16x32_bf16 v[168:171], v[76:79], v[24:27], v[168:171]
    v_mfma_f32_16x16x32_bf16 v[184:187], v[80:83], v[24:27], v[184:187]
    ds_read_b128 v[24:27], v9 offset:6144
    ds_read_b128 v[32:35], v10 offset:18432
    s_waitcnt lgkmcnt(4)
    v_mfma_f32_16x16x32_bf16 v[156:159], v[72:75], v[28:31], v[156:159]
    v_mfma_f32_16x16x32_bf16 v[172:175], v[76:79], v[28:31], v[172:175]
    s_add_u32 s65, s65, 4096
    buffer_load_dwordx4 a[208:211], v1, s[12:15], s65 offen sc1
    v_mfma_f32_16x16x32_bf16 v[188:191], v[80:83], v[28:31], v[188:191]
    ds_read_b128 v[28:31], v9 offset:30720
    s_waitcnt vmcnt(25)
    s_barrier
    s_waitcnt vmcnt(22) lgkmcnt(4)
    v_mfma_f32_16x16x32_bf16 v[144:147], v[84:87], v[16:19], v[144:147]
    v_mfma_f32_16x16x32_bf16 v[160:163], v[88:91], v[16:19], v[160:163]
    v_mfma_f32_16x16x32_bf16 v[176:179], v[92:95], v[16:19], v[176:179]
    buffer_load_dwordx4 a[212:215], v1, s[12:15], s65 offen offset:1024 sc1
    s_waitcnt lgkmcnt(1)
    v_mfma_f32_16x16x32_bf16 v[192:195], v[32:35], v[16:19], v[192:195]
    ds_read_b128 v[16:19], v8 offset:7168
    v_mfma_f32_16x16x32_bf16 v[148:151], v[84:87], v[20:23], v[148:151]
    v_mfma_f32_16x16x32_bf16 v[164:167], v[88:91], v[20:23], v[164:167]
    buffer_load_dwordx4 a[216:219], v1, s[12:15], s65 offen offset:2048 sc1
    v_mfma_f32_16x16x32_bf16 v[180:183], v[92:95], v[20:23], v[180:183]
    v_mfma_f32_16x16x32_bf16 v[196:199], v[32:35], v[20:23], v[196:199]
    ds_read_b128 v[20:23], v8 offset:31744
    v_mfma_f32_16x16x32_bf16 v[152:155], v[84:87], v[24:27], v[152:155]
    buffer_load_dwordx4 a[220:223], v1, s[12:15], s65 offen offset:3072 sc1
    v_mfma_f32_16x16x32_bf16 v[168:171], v[88:91], v[24:27], v[168:171]
    v_mfma_f32_16x16x32_bf16 v[184:187], v[92:95], v[24:27], v[184:187]
    ds_read_b128 v[24:27], v9 offset:7168
    ds_read_b128 v[32:35], v10 offset:19456
    s_waitcnt lgkmcnt(4)
    v_mfma_f32_16x16x32_bf16 v[156:159], v[84:87], v[28:31], v[156:159]
    s_add_u32 s65, s65, 4096
    buffer_load_dwordx4 a[224:227], v1, s[12:15], s65 offen sc1
    v_mfma_f32_16x16x32_bf16 v[172:175], v[88:91], v[28:31], v[172:175]
    v_mfma_f32_16x16x32_bf16 v[188:191], v[92:95], v[28:31], v[188:191]
    ds_read_b128 v[28:31], v9 offset:31744
    s_waitcnt vmcnt(23) lgkmcnt(4)
    v_mfma_f32_16x16x32_bf16 v[144:147], v[96:99], v[16:19], v[144:147]
    v_mfma_f32_16x16x32_bf16 v[160:163], v[100:103], v[16:19], v[160:163]
    buffer_load_dwordx4 a[228:231], v1, s[12:15], s65 offen offset:1024 sc1
    v_mfma_f32_16x16x32_bf16 v[176:179], v[104:107], v[16:19], v[176:179]
    s_waitcnt lgkmcnt(1)
    v_mfma_f32_16x16x32_bf16 v[192:195], v[32:35], v[16:19], v[192:195]
    ds_read_b128 v[16:19], v8 offset:21504
    v_mfma_f32_16x16x32_bf16 v[148:151], v[96:99], v[20:23], v[148:151]
    buffer_load_dwordx4 a[232:235], v1, s[12:15], s65 offen offset:2048 sc1
    v_mfma_f32_16x16x32_bf16 v[164:167], v[100:103], v[20:23], v[164:167]
    v_mfma_f32_16x16x32_bf16 v[180:183], v[104:107], v[20:23], v[180:183]
    v_mfma_f32_16x16x32_bf16 v[196:199], v[32:35], v[20:23], v[196:199]
    ds_read_b128 v[20:23], v8 offset:46080
    v_mfma_f32_16x16x32_bf16 v[152:155], v[96:99], v[24:27], v[152:155]
    v_mfma_f32_16x16x32_bf16 v[168:171], v[100:103], v[24:27], v[168:171]
    v_mfma_f32_16x16x32_bf16 v[184:187], v[104:107], v[24:27], v[184:187]
    ds_read_b128 v[24:27], v9 offset:21504
    ds_read_b128 v[32:35], v10 offset:9216
    s_waitcnt lgkmcnt(4)
    v_mfma_f32_16x16x32_bf16 v[156:159], v[96:99], v[28:31], v[156:159]
    buffer_load_dwordx4 a[236:239], v1, s[12:15], s65 offen offset:3072 sc1
    v_mfma_f32_16x16x32_bf16 v[172:175], v[100:103], v[28:31], v[172:175]
    v_mfma_f32_16x16x32_bf16 v[188:191], v[104:107], v[28:31], v[188:191]
    ds_read_b128 v[28:31], v9 offset:46080
    v_pk_mul_f32 v[192:193], v[192:193], v[194:195]
    v_pk_mul_f32 v[196:197], v[196:197], v[198:199]
    v_cvt_pk_bf16_f32 v48, v192, v193
    v_cvt_pk_bf16_f32 v49, v196, v197
    v_pk_mul_f32 v[144:145], v[144:145], v[146:147]
    v_pk_mul_f32 v[148:149], v[148:149], v[150:151]
    v_pk_mul_f32 v[152:153], v[152:153], v[154:155]
    v_pk_mul_f32 v[156:157], v[156:157], v[158:159]
    v_cvt_pk_bf16_f32 v36, v144, v145
    v_cvt_pk_bf16_f32 v37, v148, v149
    v_cvt_pk_bf16_f32 v38, v152, v153
    v_cvt_pk_bf16_f32 v39, v156, v157
    v_pk_mul_f32 v[160:161], v[160:161], v[162:163]
    v_pk_mul_f32 v[164:165], v[164:165], v[166:167]
    v_pk_mul_f32 v[168:169], v[168:169], v[170:171]
    v_pk_mul_f32 v[172:173], v[172:173], v[174:175]
    v_cvt_pk_bf16_f32 v40, v160, v161
    v_cvt_pk_bf16_f32 v41, v164, v165
    v_cvt_pk_bf16_f32 v42, v168, v169
    v_cvt_pk_bf16_f32 v43, v172, v173
    v_pk_mul_f32 v[176:177], v[176:177], v[178:179]
    v_pk_mul_f32 v[180:181], v[180:181], v[182:183]
    v_pk_mul_f32 v[184:185], v[184:185], v[186:187]
    v_pk_mul_f32 v[188:189], v[188:189], v[190:191]
    v_cvt_pk_bf16_f32 v44, v176, v177
    v_cvt_pk_bf16_f32 v45, v180, v181
    v_cvt_pk_bf16_f32 v46, v184, v185
    v_cvt_pk_bf16_f32 v47, v188, v189
    v_permlane32_swap_b32 v48, v50
    v_permlane32_swap_b32 v36, v38
    v_permlane32_swap_b32 v40, v42
    v_permlane32_swap_b32 v44, v46
    v_permlane32_swap_b32 v49, v51
    v_permlane32_swap_b32 v37, v39
    v_permlane32_swap_b32 v41, v43
    v_permlane32_swap_b32 v45, v47
    v_permlane16_swap_b32 v48, v49
    v_permlane16_swap_b32 v50, v51
    buffer_store_dwordx4 v[48:51], v12, s[12:15], s31 offen sc1
    v_permlane16_swap_b32 v36, v37
    v_permlane16_swap_b32 v38, v39
    buffer_store_dwordx4 v[36:39], v11, s[12:15], s29 offen sc1
    v_permlane16_swap_b32 v40, v41
    v_permlane16_swap_b32 v42, v43
    buffer_store_dwordx4 v[40:43], v11, s[12:15], s29 offen offset:256 sc1
    v_permlane16_swap_b32 v44, v45
    v_permlane16_swap_b32 v46, v47
    buffer_store_dwordx4 v[44:47], v11, s[12:15], s29 offen offset:512 sc1
    s_waitcnt lgkmcnt(4)
    v_mfma_f32_16x16x32_bf16 v[200:203], a[176:179], v[16:19], v[200:203]
    s_add_u32 s29, s29, 110592
    s_add_u32 s31, s31, 110592
    v_mfma_f32_16x16x32_bf16 v[216:219], a[180:183], v[16:19], v[216:219]
    s_and_b32 s4, s52, 1
    v_mfma_f32_16x16x32_bf16 v[232:235], a[184:187], v[16:19], v[232:235]
    s_add_u32 s65, s65, 4096
    buffer_load_dwordx4 a[56:59], v1, s[12:15], s65 offen sc1
    s_waitcnt lgkmcnt(1)
    v_mfma_f32_16x16x32_bf16 v[248:251], v[32:35], v[16:19], v[248:251]
    ds_read_b128 v[16:19], v8 offset:22528
    v_mfma_f32_16x16x32_bf16 v[204:207], a[176:179], v[20:23], v[204:207]
    buffer_load_dwordx4 a[88:91], v1, s[12:15], s65 offen offset:1024 sc1
    v_mfma_f32_16x16x32_bf16 v[220:223], a[180:183], v[20:23], v[220:223]
    buffer_load_dwordx4 a[96:99], v1, s[12:15], s65 offen offset:2048 sc1
    v_mfma_f32_16x16x32_bf16 v[236:239], a[184:187], v[20:23], v[236:239]
    buffer_load_dwordx4 a[64:67], v1, s[12:15], s65 offen offset:3072 sc1
    v_mfma_f32_16x16x32_bf16 v[252:255], v[32:35], v[20:23], v[252:255]
    ds_read_b128 v[20:23], v8 offset:47104
    v_mfma_f32_16x16x32_bf16 v[208:211], a[176:179], v[24:27], v[208:211]
    s_mul_i32 s5, s4, 55296
    v_add_u32 v5, s5, v1
    v_mfma_f32_16x16x32_bf16 v[224:227], a[180:183], v[24:27], v[224:227]
    s_sub_u32 s5, 55296, s5
    v_add_u32 v6, s5, v1
    v_mfma_f32_16x16x32_bf16 v[240:243], a[184:187], v[24:27], v[240:243]
    ds_read_b128 v[24:27], v9 offset:22528
    ds_read_b128 v[32:35], v10 offset:10240
    s_waitcnt lgkmcnt(4)
    v_mfma_f32_16x16x32_bf16 v[212:215], a[176:179], v[28:31], v[212:215]
    v_mfma_f32_16x16x32_bf16 v[228:231], a[180:183], v[28:31], v[228:231]
    v_mfma_f32_16x16x32_bf16 v[244:247], a[184:187], v[28:31], v[244:247]
    ds_read_b128 v[28:31], v9 offset:47104
    s_waitcnt lgkmcnt(4)
    v_mfma_f32_16x16x32_bf16 v[200:203], a[188:191], v[16:19], v[200:203]
    s_add_u32 s65, s65, 4096
    buffer_load_dwordx4 a[104:107], v1, s[12:15], s65 offen sc1
    v_mfma_f32_16x16x32_bf16 v[216:219], a[192:195], v[16:19], v[216:219]
    buffer_load_dwordx4 a[108:111], v1, s[12:15], s65 offen offset:1024 sc1
    v_mfma_f32_16x16x32_bf16 v[232:235], a[196:199], v[16:19], v[232:235]
    s_waitcnt lgkmcnt(1)
    v_mfma_f32_16x16x32_bf16 v[248:251], v[32:35], v[16:19], v[248:251]
    ds_read_b128 v[16:19], v8 offset:23552
    v_mfma_f32_16x16x32_bf16 v[204:207], a[188:191], v[20:23], v[204:207]
    v_mfma_f32_16x16x32_bf16 v[220:223], a[192:195], v[20:23], v[220:223]
    v_mfma_f32_16x16x32_bf16 v[236:239], a[196:199], v[20:23], v[236:239]
    v_mfma_f32_16x16x32_bf16 v[252:255], v[32:35], v[20:23], v[252:255]
    ds_read_b128 v[20:23], v8 offset:48128
    v_mfma_f32_16x16x32_bf16 v[208:211], a[188:191], v[24:27], v[208:211]
    v_mfma_f32_16x16x32_bf16 v[224:227], a[192:195], v[24:27], v[224:227]
    v_mfma_f32_16x16x32_bf16 v[240:243], a[196:199], v[24:27], v[240:243]
    ds_read_b128 v[24:27], v9 offset:23552
    ds_read_b128 v[32:35], v10 offset:11264
    s_waitcnt lgkmcnt(4)
    v_mfma_f32_16x16x32_bf16 v[212:215], a[188:191], v[28:31], v[212:215]
    v_mfma_f32_16x16x32_bf16 v[228:231], a[192:195], v[28:31], v[228:231]
    v_mfma_f32_16x16x32_bf16 v[244:247], a[196:199], v[28:31], v[244:247]
    ds_read_b128 v[28:31], v9 offset:48128
    s_waitcnt vmcnt(32)
    s_barrier
    s_waitcnt lgkmcnt(4)
    v_mfma_f32_16x16x32_bf16 v[200:203], a[200:203], v[16:19], v[200:203]
    v_mfma_f32_16x16x32_bf16 v[216:219], a[84:87], v[16:19], v[216:219]
    v_mfma_f32_16x16x32_bf16 v[232:235], a[136:139], v[16:19], v[232:235]
    buffer_load_dwordx4 a[112:115], v1, s[12:15], s65 offen offset:2048 sc1
    s_waitcnt lgkmcnt(1)
    v_mfma_f32_16x16x32_bf16 v[248:251], v[32:35], v[16:19], v[248:251]
    ds_read_b128 v[16:19], v8 offset:12288
    v_mfma_f32_16x16x32_bf16 v[204:207], a[200:203], v[20:23], v[204:207]
    v_mfma_f32_16x16x32_bf16 v[220:223], a[84:87], v[20:23], v[220:223]
    v_mfma_f32_16x16x32_bf16 v[236:239], a[136:139], v[20:23], v[236:239]
    v_mfma_f32_16x16x32_bf16 v[252:255], v[32:35], v[20:23], v[252:255]
    ds_read_b128 v[20:23], v8 offset:36864
    v_mfma_f32_16x16x32_bf16 v[208:211], a[200:203], v[24:27], v[208:211]
    buffer_load_dwordx4 a[116:119], v1, s[12:15], s65 offen offset:3072 sc1
    v_mfma_f32_16x16x32_bf16 v[224:227], a[84:87], v[24:27], v[224:227]
    v_mfma_f32_16x16x32_bf16 v[240:243], a[136:139], v[24:27], v[240:243]
    ds_read_b128 v[24:27], v9 offset:12288
    ds_read_b128 v[32:35], v10 offset:12288
    s_waitcnt lgkmcnt(4)
    v_mfma_f32_16x16x32_bf16 v[212:215], a[200:203], v[28:31], v[212:215]
    v_mfma_f32_16x16x32_bf16 v[228:231], a[84:87], v[28:31], v[228:231]
    s_add_u32 s65, s65, 4096
    buffer_load_dwordx4 a[72:75], v1, s[12:15], s65 offen sc1
    v_mfma_f32_16x16x32_bf16 v[244:247], a[136:139], v[28:31], v[244:247]
    ds_read_b128 v[28:31], v9 offset:36864
    s_waitcnt lgkmcnt(4)
    v_mfma_f32_16x16x32_bf16 v[200:203], a[140:143], v[16:19], v[200:203]
    v_mfma_f32_16x16x32_bf16 v[216:219], a[144:147], v[16:19], v[216:219]
    v_mfma_f32_16x16x32_bf16 v[232:235], a[148:151], v[16:19], v[232:235]
    buffer_load_dwordx4 a[76:79], v1, s[12:15], s65 offen offset:1024 sc1
    s_waitcnt lgkmcnt(1)
    v_mfma_f32_16x16x32_bf16 v[248:251], v[32:35], v[16:19], v[248:251]
    ds_read_b128 v[16:19], v8 offset:13312
    v_mfma_f32_16x16x32_bf16 v[204:207], a[140:143], v[20:23], v[204:207]
    v_mfma_f32_16x16x32_bf16 v[220:223], a[144:147], v[20:23], v[220:223]
    v_mfma_f32_16x16x32_bf16 v[236:239], a[148:151], v[20:23], v[236:239]
    buffer_load_dwordx4 a[120:123], v1, s[12:15], s65 offen offset:2048 sc1
    v_mfma_f32_16x16x32_bf16 v[252:255], v[32:35], v[20:23], v[252:255]
    ds_read_b128 v[20:23], v8 offset:37888
    v_mfma_f32_16x16x32_bf16 v[208:211], a[140:143], v[24:27], v[208:211]
    v_mfma_f32_16x16x32_bf16 v[224:227], a[144:147], v[24:27], v[224:227]
    v_mfma_f32_16x16x32_bf16 v[240:243], a[148:151], v[24:27], v[240:243]
    ds_read_b128 v[24:27], v9 offset:13312
    ds_read_b128 v[32:35], v10 offset:13312
    s_waitcnt lgkmcnt(4)
    v_mfma_f32_16x16x32_bf16 v[212:215], a[140:143], v[28:31], v[212:215]
    buffer_load_dwordx4 a[124:127], v1, s[12:15], s65 offen offset:3072 sc1
    v_mfma_f32_16x16x32_bf16 v[228:231], a[144:147], v[28:31], v[228:231]
    v_mfma_f32_16x16x32_bf16 v[244:247], a[148:151], v[28:31], v[244:247]
    ds_read_b128 v[28:31], v9 offset:37888
    s_waitcnt vmcnt(12)
    s_barrier
    s_cmp_eq_u32 s59, 1
    s_cbranch_scc0 L_slow_52
    buffer_store_dword v15, v14, s[12:15], s33 offen
L_back_53:
    s_waitcnt lgkmcnt(4)
    v_mfma_f32_16x16x32_bf16 v[200:203], a[152:155], v[16:19], v[200:203]
    v_mfma_f32_16x16x32_bf16 v[216:219], a[156:159], v[16:19], v[216:219]
    v_mfma_f32_16x16x32_bf16 v[232:235], a[160:163], v[16:19], v[232:235]
    s_add_u32 s65, s65, 4096
    buffer_load_dwordx4 a[128:131], v1, s[12:15], s65 offen sc1
    s_waitcnt lgkmcnt(1)
    v_mfma_f32_16x16x32_bf16 v[248:251], v[32:35], v[16:19], v[248:251]
    ds_read_b128 v[16:19], v8 offset:14336
    v_mfma_f32_16x16x32_bf16 v[204:207], a[152:155], v[20:23], v[204:207]
    v_mfma_f32_16x16x32_bf16 v[220:223], a[156:159], v[20:23], v[220:223]
    v_mfma_f32_16x16x32_bf16 v[236:239], a[160:163], v[20:23], v[236:239]
    buffer_load_dwordx4 a[132:135], v1, s[12:15], s65 offen offset:1024 sc1
    v_mfma_f32_16x16x32_bf16 v[252:255], v[32:35], v[20:23], v[252:255]
    ds_read_b128 v[20:23], v8 offset:38912
    v_mfma_f32_16x16x32_bf16 v[208:211], a[152:155], v[24:27], v[208:211]
    v_mfma_f32_16x16x32_bf16 v[224:227], a[156:159], v[24:27], v[224:227]
    v_mfma_f32_16x16x32_bf16 v[240:243], a[160:163], v[24:27], v[240:243]
    ds_read_b128 v[24:27], v9 offset:14336
    ds_read_b128 v[32:35], v10 offset:14336
    s_waitcnt lgkmcnt(4)
    v_mfma_f32_16x16x32_bf16 v[212:215], a[152:155], v[28:31], v[212:215]
    buffer_load_dwordx4 a[80:83], v1, s[12:15], s65 offen offset:2048 sc1
    v_mfma_f32_16x16x32_bf16 v[228:231], a[156:159], v[28:31], v[228:231]
    v_mfma_f32_16x16x32_bf16 v[244:247], a[160:163], v[28:31], v[244:247]
    ds_read_b128 v[28:31], v9 offset:38912
    s_waitcnt lgkmcnt(4)
    v_mfma_f32_16x16x32_bf16 v[200:203], a[0:3], v[16:19], v[200:203]
    v_mfma_f32_16x16x32_bf16 v[216:219], a[4:7], v[16:19], v[216:219]
    v_mfma_f32_16x16x32_bf16 v[232:235], a[8:11], v[16:19], v[232:235]
    buffer_load_dwordx4 a[164:167], v1, s[12:15], s65 offen offset:3072 sc1
    s_waitcnt lgkmcnt(1)
    v_mfma_f32_16x16x32_bf16 v[248:251], v[32:35], v[16:19], v[248:251]
    ds_read_b128 v[16:19], v8 offset:15360
    v_mfma_f32_16x16x32_bf16 v[204:207], a[0:3], v[20:23], v[204:207]
    v_mfma_f32_16x16x32_bf16 v[220:223], a[4:7], v[20:23], v[220:223]
    s_add_u32 s65, s65, 4096
    buffer_load_dwordx4 a[168:171], v1, s[12:15], s65 offen sc1
    v_mfma_f32_16x16x32_bf16 v[236:239], a[8:11], v[20:23], v[236:239]
    v_mfma_f32_16x16x32_bf16 v[252:255], v[32:35], v[20:23], v[252:255]
    ds_read_b128 v[20:23], v8 offset:39936
    v_mfma_f32_16x16x32_bf16 v[208:211], a[0:3], v[24:27], v[208:211]
    v_mfma_f32_16x16x32_bf16 v[224:227], a[4:7], v[24:27], v[224:227]
    buffer_load_dwordx4 a[172:175], v1, s[12:15], s65 offen offset:1024 sc1
    v_mfma_f32_16x16x32_bf16 v[240:243], a[8:11], v[24:27], v[240:243]
    ds_read_b128 v[24:27], v9 offset:15360
    ds_read_b128 v[32:35], v10 offset:15360
    s_waitcnt lgkmcnt(4)
    v_mfma_f32_16x16x32_bf16 v[212:215], a[0:3], v[28:31], v[212:215]
    v_mfma_f32_16x16x32_bf16 v[228:231], a[4:7], v[28:31], v[228:231]
    v_mfma_f32_16x16x32_bf16 v[244:247], a[8:11], v[28:31], v[244:247]
    ds_read_b128 v[28:31], v9 offset:39936
    s_barrier
    s_waitcnt lgkmcnt(4)
    v_mfma_f32_16x16x32_bf16 v[200:203], a[12:15], v[16:19], v[200:203]
    buffer_load_dwordx4 v[184:187], v1, s[12:15], s65 offen offset:2048 sc1
    v_mfma_f32_16x16x32_bf16 v[216:219], a[16:19], v[16:19], v[216:219]
    v_mfma_f32_16x16x32_bf16 v[232:235], v[56:59], v[16:19], v[232:235]
    buffer_load_dwordx4 v[188:191], v1, s[12:15], s65 offen offset:3072 sc1
    s_waitcnt lgkmcnt(1)
    v_mfma_f32_16x16x32_bf16 v[248:251], v[32:35], v[16:19], v[248:251]
    ds_read_b128 v[16:19], v8 offset:16384
    v_mfma_f32_16x16x32_bf16 v[204:207], a[12:15], v[20:23], v[204:207]
    v_mfma_f32_16x16x32_bf16 v[220:223], a[16:19], v[20:23], v[220:223]
    v_mfma_f32_16x16x32_bf16 v[236:239], v[56:59], v[20:23], v[236:239]
    s_add_u32 s65, s65, 4096
    buffer_load_dwordx4 v[192:195], v1, s[12:15], s65 offen sc1
    v_mfma_f32_16x16x32_bf16 v[252:255], v[32:35], v[20:23], v[252:255]
    ds_read_b128 v[20:23], v8 offset:40960
    v_mfma_f32_16x16x32_bf16 v[208:211], a[12:15], v[24:27], v[208:211]
    v_mfma_f32_16x16x32_bf16 v[224:227], a[16:19], v[24:27], v[224:227]
    buffer_load_dwordx4 v[196:199], v1, s[12:15], s65 offen offset:1024 sc1
    v_mfma_f32_16x16x32_bf16 v[240:243], v[56:59], v[24:27], v[240:243]
    ds_read_b128 v[24:27], v9 offset:16384
    ds_read_b128 v[32:35], v10 offset:16384
    s_waitcnt lgkmcnt(4)
    v_mfma_f32_16x16x32_bf16 v[212:215], a[12:15], v[28:31], v[212:215]
    v_mfma_f32_16x16x32_bf16 v[228:231], a[16:19], v[28:31], v[228:231]
    v_mfma_f32_16x16x32_bf16 v[244:247], v[56:59], v[28:31], v[244:247]
    ds_read_b128 v[28:31], v9 offset:40960
    s_load_dwordx16 s[36:51], s[34:35], s32
    s_waitcnt lgkmcnt(4)
    v_mfma_f32_16x16x32_bf16 v[200:203], v[60:63], v[16:19], v[200:203]
    v_mfma_f32_16x16x32_bf16 v[216:219], v[64:67], v[16:19], v[216:219]
    v_mfma_f32_16x16x32_bf16 v[232:235], v[68:71], v[16:19], v[232:235]
    buffer_load_dwordx4 a[176:179], v1, s[12:15], s65 offen offset:2048 sc1
    s_waitcnt lgkmcnt(1)
    v_mfma_f32_16x16x32_bf16 v[248:251], v[32:35], v[16:19], v[248:251]
    ds_read_b128 v[16:19], v8 offset:17408
    v_mfma_f32_16x16x32_bf16 v[204:207], v[60:63], v[20:23], v[204:207]
    v_mfma_f32_16x16x32_bf16 v[220:223], v[64:67], v[20:23], v[220:223]
    v_mfma_f32_16x16x32_bf16 v[236:239], v[68:71], v[20:23], v[236:239]
    buffer_load_dwordx4 a[180:183], v1, s[12:15], s65 offen offset:3072 sc1
    v_mfma_f32_16x16x32_bf16 v[252:255], v[32:35], v[20:23], v[252:255]
    ds_read_b128 v[20:23], v8 offset:41984
    v_mfma_f32_16x16x32_bf16 v[208:211], v[60:63], v[24:27], v[208:211]
    v_mfma_f32_16x16x32_bf16 v[224:227], v[64:67], v[24:27], v[224:227]
    s_add_u32 s65, s65, 4096
    buffer_load_dwordx4 a[184:187], v1, s[12:15], s65 offen sc1
    v_mfma_f32_16x16x32_bf16 v[240:243], v[68:71], v[24:27], v[240:243]
    ds_read_b128 v[24:27], v9 offset:17408
    ds_read_b128 v[32:35], v10 offset:17408
    s_waitcnt lgkmcnt(4)
    v_mfma_f32_16x16x32_bf16 v[212:215], v[60:63], v[28:31], v[212:215]
    v_mfma_f32_16x16x32_bf16 v[228:231], v[64:67], v[28:31], v[228:231]
    v_mfma_f32_16x16x32_bf16 v[244:247], v[68:71], v[28:31], v[244:247]
    ds_read_b128 v[28:31], v9 offset:41984
    s_waitcnt lgkmcnt(4)
    v_mfma_f32_16x16x32_bf16 v[200:203], v[72:75], v[16:19], v[200:203]
    buffer_load_dwordx4 a[188:191], v1, s[12:15], s65 offen offset:1024 sc1
    v_mfma_f32_16x16x32_bf16 v[216:219], v[76:79], v[16:19], v[216:219]
    s_waitcnt lgkmcnt(0)
    s_xor_b64 s[36:37], s[36:37], s[6:7]
    s_xor_b64 s[38:39], s[38:39], s[6:7]
    s_or_b64 s[36:37], s[36:37], s[38:39]
    v_mfma_f32_16x16x32_bf16 v[232:235], v[80:83], v[16:19], v[232:235]
    buffer_load_dwordx4 a[192:195], v1, s[12:15], s65 offen offset:2048 sc1
    v_mfma_f32_16x16x32_bf16 v[248:251], v[32:35], v[16:19], v[248:251]
    ds_read_b128 v[16:19], v8 offset:18432
    v_mfma_f32_16x16x32_bf16 v[204:207], v[72:75], v[20:23], v[204:207]
    buffer_load_dwordx4 a[196:199], v1, s[12:15], s65 offen offset:3072 sc1
    v_mfma_f32_16x16x32_bf16 v[220:223], v[76:79], v[20:23], v[220:223]
    s_xor_b64 s[40:41], s[40:41], s[6:7]
    s_or_b64 s[36:37], s[36:37], s[40:41]
    v_mfma_f32_16x16x32_bf16 v[236:239], v[80:83], v[20:23], v[236:239]
    s_xor_b64 s[42:43], s[42:43], s[6:7]
    s_or_b64 s[36:37], s[36:37], s[42:43]
    v_mfma_f32_16x16x32_bf16 v[252:255], v[32:35], v[20:23], v[252:255]
    ds_read_b128 v[20:23], v8 offset:43008
    v_mfma_f32_16x16x32_bf16 v[208:211], v[72:75], v[24:27], v[208:211]
    s_xor_b64 s[44:45], s[44:45], s[6:7]
    s_or_b64 s[36:37], s[36:37], s[44:45]
    v_mfma_f32_16x16x32_bf16 v[224:227], v[76:79], v[24:27], v[224:227]
    s_xor_b64 s[46:47], s[46:47], s[6:7]
    s_or_b64 s[36:37], s[36:37], s[46:47]
    v_mfma_f32_16x16x32_bf16 v[240:243], v[80:83], v[24:27], v[240:243]
    ds_read_b128 v[24:27], v9 offset:18432
    ds_read_b128 v[32:35], v10 offset:18432
    v_mfma_f32_16x16x32_bf16 v[212:215], v[72:75], v[28:31], v[212:215]
    s_xor_b64 s[48:49], s[48:49], s[6:7]
    s_or_b64 s[36:37], s[36:37], s[48:49]
    v_mfma_f32_16x16x32_bf16 v[228:231], v[76:79], v[28:31], v[228:231]
    s_xor_b64 s[50:51], s[50:51], s[6:7]
    s_or_b64 s[36:37], s[36:37], s[50:51]
    v_mfma_f32_16x16x32_bf16 v[244:247], v[80:83], v[28:31], v[244:247]
    ds_read_b128 v[28:31], v9 offset:43008
    s_waitcnt lgkmcnt(4)
    v_mfma_f32_16x16x32_bf16 v[200:203], v[84:87], v[16:19], v[200:203]
    s_add_u32 s65, s65, 4096
    buffer_load_dwordx4 a[200:203], v1, s[12:15], s65 offen sc1
    v_mfma_f32_16x16x32_bf16 v[216:219], v[88:91], v[16:19], v[216:219]
    buffer_load_dwordx4 a[84:87], v1, s[12:15], s65 offen offset:1024 sc1
    v_mfma_f32_16x16x32_bf16 v[232:235], v[92:95], v[16:19], v[232:235]
    s_mov_b32 s3, 0
    s_branch L_first_55
L_retry_54:
    s_waitcnt lgkmcnt(0)
    s_add_u32 s3, s3, 1
    s_cmp_gt_u32 s3, 0x20000
    s_cbranch_scc1 L_done_56
    s_cmp_lt_u32 s3, 32
    s_cbranch_scc0 L_else_57
    s_add_u32 s32, s32, 128
    s_load_dwordx16 s[36:51], s[34:35], s32
    s_branch L_join_58
L_else_57:
    s_load_dwordx16 s[36:51], s[34:35], s32 glc
L_join_58:
    s_waitcnt lgkmcnt(0)
    s_xor_b64 s[36:37], s[36:37], s[6:7]
    s_xor_b64 s[38:39], s[38:39], s[6:7]
    s_or_b64 s[36:37], s[36:37], s[38:39]
    s_xor_b64 s[40:41], s[40:41], s[6:7]
    s_or_b64 s[36:37], s[36:37], s[40:41]
    s_xor_b64 s[42:43], s[42:43], s[6:7]
    s_or_b64 s[36:37], s[36:37], s[42:43]
    s_xor_b64 s[44:45], s[44:45], s[6:7]
    s_or_b64 s[36:37], s[36:37], s[44:45]
    s_xor_b64 s[46:47], s[46:47], s[6:7]
    s_or_b64 s[36:37], s[36:37], s[46:47]
    s_xor_b64 s[48:49], s[48:49], s[6:7]
    s_or_b64 s[36:37], s[36:37], s[48:49]
    s_xor_b64 s[50:51], s[50:51], s[6:7]
    s_or_b64 s[36:37], s[36:37], s[50:51]
L_first_55:
    s_cmp_lg_u64 s[36:37], 0
    s_cbranch_scc1 L_retry_54
L_done_56:
    s_waitcnt lgkmcnt(1)
    v_mfma_f32_16x16x32_bf16 v[248:251], v[32:35], v[16:19], v[248:251]
    ds_read_b128 v[16:19], v8 offset:19456
    v_mfma_f32_16x16x32_bf16 v[204:207], v[84:87], v[20:23], v[204:207]
    buffer_load_dwordx4 a[136:139], v5, s[12:15], s1 offen sc1
    v_mfma_f32_16x16x32_bf16 v[220:223], v[88:91], v[20:23], v[220:223]
    v_mfma_f32_16x16x32_bf16 v[236:239], v[92:95], v[20:23], v[236:239]
    buffer_load_dwordx4 a[140:143], v6, s[12:15], s1 offen sc1
    v_mfma_f32_16x16x32_bf16 v[252:255], v[32:35], v[20:23], v[252:255]
    ds_read_b128 v[20:23], v8 offset:44032
    v_mfma_f32_16x16x32_bf16 v[208:211], v[84:87], v[24:27], v[208:211]
    v_mfma_f32_16x16x32_bf16 v[224:227], v[88:91], v[24:27], v[224:227]
    v_mfma_f32_16x16x32_bf16 v[240:243], v[92:95], v[24:27], v[240:243]
    ds_read_b128 v[24:27], v9 offset:19456
    ds_read_b128 v[32:35], v10 offset:19456
    s_waitcnt lgkmcnt(4)
    v_mfma_f32_16x16x32_bf16 v[212:215], v[84:87], v[28:31], v[212:215]
    buffer_load_dwordx4 a[144:147], v5, s[12:15], s1 offen offset:1024 sc1
    v_mfma_f32_16x16x32_bf16 v[228:231], v[88:91], v[28:31], v[228:231]
    v_mfma_f32_16x16x32_bf16 v[244:247], v[92:95], v[28:31], v[244:247]
    ds_read_b128 v[28:31], v9 offset:44032
    s_waitcnt lgkmcnt(4)
    v_mfma_f32_16x16x32_bf16 v[200:203], v[96:99], v[16:19], v[200:203]
    buffer_load_dwordx4 a[148:151], v6, s[12:15], s1 offen offset:1024 sc1
    v_mfma_f32_16x16x32_bf16 v[216:219], v[100:103], v[16:19], v[216:219]
    v_mfma_f32_16x16x32_bf16 v[232:235], v[104:107], v[16:19], v[232:235]
    s_waitcnt lgkmcnt(1)
    v_mfma_f32_16x16x32_bf16 v[248:251], v[32:35], v[16:19], v[248:251]
    v_mfma_f32_16x16x32_bf16 v[204:207], v[96:99], v[20:23], v[204:207]
    buffer_load_dwordx4 a[152:155], v5, s[12:15], s1 offen offset:2048 sc1
    v_mfma_f32_16x16x32_bf16 v[220:223], v[100:103], v[20:23], v[220:223]
    v_mfma_f32_16x16x32_bf16 v[236:239], v[104:107], v[20:23], v[236:239]
    v_mfma_f32_16x16x32_bf16 v[252:255], v[32:35], v[20:23], v[252:255]
    v_mfma_f32_16x16x32_bf16 v[208:211], v[96:99], v[24:27], v[208:211]
    buffer_load_dwordx4 a[156:159], v6, s[12:15], s1 offen offset:2048 sc1
    v_mfma_f32_16x16x32_bf16 v[224:227], v[100:103], v[24:27], v[224:227]
    v_mfma_f32_16x16x32_bf16 v[240:243], v[104:107], v[24:27], v[240:243]
    s_waitcnt lgkmcnt(0)
    v_mfma_f32_16x16x32_bf16 v[212:215], v[96:99], v[28:31], v[212:215]
    v_mfma_f32_16x16x32_bf16 v[228:231], v[100:103], v[28:31], v[228:231]
    v_mfma_f32_16x16x32_bf16 v[244:247], v[104:107], v[28:31], v[244:247]
    buffer_load_dwordx4 a[160:163], v5, s[12:15], s1 offen offset:3072 sc1
    buffer_load_dwordx4 a[0:3], v6, s[12:15], s1 offen offset:3072 sc1
    v_pk_mul_f32 v[248:249], v[248:249], v[250:251]
    v_pk_mul_f32 v[252:253], v[252:253], v[254:255]
    v_cvt_pk_bf16_f32 v48, v248, v249
    v_cvt_pk_bf16_f32 v49, v252, v253
    v_pk_mul_f32 v[200:201], v[200:201], v[202:203]
    v_pk_mul_f32 v[204:205], v[204:205], v[206:207]
    v_pk_mul_f32 v[208:209], v[208:209], v[210:211]
    v_pk_mul_f32 v[212:213], v[212:213], v[214:215]
    v_cvt_pk_bf16_f32 v36, v200, v201
    v_cvt_pk_bf16_f32 v37, v204, v205
    v_cvt_pk_bf16_f32 v38, v208, v209
    v_cvt_pk_bf16_f32 v39, v212, v213
    v_pk_mul_f32 v[216:217], v[216:217], v[218:219]
    v_pk_mul_f32 v[220:221], v[220:221], v[222:223]
    v_pk_mul_f32 v[224:225], v[224:225], v[226:227]
    v_pk_mul_f32 v[228:229], v[228:229], v[230:231]
    v_cvt_pk_bf16_f32 v40, v216, v217
    v_cvt_pk_bf16_f32 v41, v220, v221
    v_cvt_pk_bf16_f32 v42, v224, v225
    v_cvt_pk_bf16_f32 v43, v228, v229
    v_pk_mul_f32 v[232:233], v[232:233], v[234:235]
    v_pk_mul_f32 v[236:237], v[236:237], v[238:239]
    v_pk_mul_f32 v[240:241], v[240:241], v[242:243]
    v_pk_mul_f32 v[244:245], v[244:245], v[246:247]
    v_cvt_pk_bf16_f32 v44, v232, v233
    v_cvt_pk_bf16_f32 v45, v236, v237
    v_cvt_pk_bf16_f32 v46, v240, v241
    v_cvt_pk_bf16_f32 v47, v244, v245
    v_permlane32_swap_b32 v48, v50
    v_permlane32_swap_b32 v36, v38
    v_permlane32_swap_b32 v40, v42
    v_permlane32_swap_b32 v44, v46
    v_permlane32_swap_b32 v49, v51
    v_permlane32_swap_b32 v37, v39
    v_permlane32_swap_b32 v41, v43
    v_permlane32_swap_b32 v45, v47
    v_permlane16_swap_b32 v48, v49
    v_permlane16_swap_b32 v50, v51
    buffer_store_dwordx4 v[48:51], v12, s[12:15], s31 offen sc1
    v_permlane16_swap_b32 v36, v37
    v_permlane16_swap_b32 v38, v39
    buffer_store_dwordx4 v[36:39], v11, s[12:15], s29 offen sc1
    v_permlane16_swap_b32 v40, v41
    v_permlane16_swap_b32 v42, v43
    buffer_store_dwordx4 v[40:43], v11, s[12:15], s29 offen offset:256 sc1
    v_permlane16_swap_b32 v44, v45
    v_permlane16_swap_b32 v46, v47
    buffer_store_dwordx4 v[44:47], v11, s[12:15], s29 offen offset:512 sc1
    s_waitcnt vmcnt(11)
    v_mfma_f32_16x16x32_bf16 v[144:147], a[240:243], a[136:139], 0
    s_lshl_b32 s32, s56, 12
    s_add_u32 s32, s32, 262208
    v_mfma_f32_16x16x32_bf16 v[148:151], a[20:23], a[136:139], 0
    v_mfma_f32_16x16x32_bf16 v[152:155], a[24:27], a[136:139], 0
    v_mfma_f32_16x16x32_bf16 v[156:159], a[28:31], a[136:139], 0
    s_add_u32 s1, s1, 4096
    buffer_load_dwordx4 a[4:7], v5, s[12:15], s1 offen sc1
    v_mfma_f32_16x16x32_bf16 v[160:163], a[32:35], a[136:139], 0
    s_waitcnt vmcnt(11)
    v_mfma_f32_16x16x32_bf16 v[164:167], a[240:243], a[140:143], 0
    v_mfma_f32_16x16x32_bf16 v[168:171], a[20:23], a[140:143], 0
    v_mfma_f32_16x16x32_bf16 v[172:175], a[24:27], a[140:143], 0
    v_mfma_f32_16x16x32_bf16 v[176:179], a[28:31], a[140:143], 0
    v_mfma_f32_16x16x32_bf16 v[180:183], a[32:35], a[140:143], 0
    s_waitcnt vmcnt(10)
    v_mfma_f32_16x16x32_bf16 v[144:147], a[36:39], a[144:147], v[144:147]
    buffer_load_dwordx4 a[8:11], v6, s[12:15], s1 offen sc1
    v_mfma_f32_16x16x32_bf16 v[148:151], a[40:43], a[144:147], v[148:151]
    v_mfma_f32_16x16x32_bf16 v[152:155], a[44:47], a[144:147], v[152:155]
    v_mfma_f32_16x16x32_bf16 v[156:159], a[48:51], a[144:147], v[156:159]
    buffer_load_dwordx4 a[12:15], v5, s[12:15], s1 offen offset:1024 sc1
    v_mfma_f32_16x16x32_bf16 v[160:163], a[52:55], a[144:147], v[160:163]
    s_waitcnt vmcnt(11)
    v_mfma_f32_16x16x32_bf16 v[164:167], a[36:39], a[148:151], v[164:167]
    v_mfma_f32_16x16x32_bf16 v[168:171], a[40:43], a[148:151], v[168:171]
    buffer_load_dwordx4 a[16:19], v6, s[12:15], s1 offen offset:1024 sc1
    v_mfma_f32_16x16x32_bf16 v[172:175], a[44:47], a[148:151], v[172:175]
    v_mfma_f32_16x16x32_bf16 v[176:179], a[48:51], a[148:151], v[176:179]
    v_mfma_f32_16x16x32_bf16 v[180:183], a[52:55], a[148:151], v[180:183]
    s_waitcnt vmcnt(11)
    v_mfma_f32_16x16x32_bf16 v[144:147], a[60:63], a[152:155], v[144:147]
    buffer_load_dwordx4 v[56:59], v5, s[12:15], s1 offen offset:2048 sc1
    v_mfma_f32_16x16x32_bf16 v[148:151], a[92:95], a[152:155], v[148:151]
    v_mfma_f32_16x16x32_bf16 v[152:155], a[100:103], a[152:155], v[152:155]
    v_mfma_f32_16x16x32_bf16 v[156:159], a[68:71], a[152:155], v[156:159]
    buffer_load_dwordx4 v[60:63], v6, s[12:15], s1 offen offset:2048 sc1
    v_mfma_f32_16x16x32_bf16 v[160:163], v[108:111], a[152:155], v[160:163]
    s_waitcnt vmcnt(12)
    v_mfma_f32_16x16x32_bf16 v[164:167], a[60:63], a[156:159], v[164:167]
    v_mfma_f32_16x16x32_bf16 v[168:171], a[92:95], a[156:159], v[168:171]
    v_mfma_f32_16x16x32_bf16 v[172:175], a[100:103], a[156:159], v[172:175]
    v_mfma_f32_16x16x32_bf16 v[176:179], a[68:71], a[156:159], v[176:179]
    v_mfma_f32_16x16x32_bf16 v[180:183], v[108:111], a[156:159], v[180:183]
    s_waitcnt vmcnt(11)
    v_mfma_f32_16x16x32_bf16 v[144:147], v[112:115], a[160:163], v[144:147]
    buffer_load_dwordx4 v[64:67], v5, s[12:15], s1 offen offset:3072 sc1
    v_mfma_f32_16x16x32_bf16 v[148:151], v[116:119], a[160:163], v[148:151]
    v_mfma_f32_16x16x32_bf16 v[152:155], v[120:123], a[160:163], v[152:155]
    v_mfma_f32_16x16x32_bf16 v[156:159], v[124:127], a[160:163], v[156:159]
    v_mfma_f32_16x16x32_bf16 v[160:163], v[128:131], a[160:163], v[160:163]
    s_waitcnt vmcnt(11)
    v_mfma_f32_16x16x32_bf16 v[164:167], v[112:115], a[0:3], v[164:167]
    buffer_load_dwordx4 v[68:71], v6, s[12:15], s1 offen offset:3072 sc1
    v_mfma_f32_16x16x32_bf16 v[168:171], v[116:119], a[0:3], v[168:171]
    v_mfma_f32_16x16x32_bf16 v[172:175], v[120:123], a[0:3], v[172:175]
    v_mfma_f32_16x16x32_bf16 v[176:179], v[124:127], a[0:3], v[176:179]
    v_mfma_f32_16x16x32_bf16 v[180:183], v[128:131], a[0:3], v[180:183]
    s_waitcnt vmcnt(8)
    s_barrier
    s_cmp_eq_u32 s59, 1
    s_cbranch_scc0 L_slow_59
    buffer_store_dword v15, v14, s[12:15], s33 offen offset:64
L_back_60:
    s_add_u32 s1, s1, 4096
    buffer_load_dwordx4 v[72:75], v5, s[12:15], s1 offen sc1
    s_waitcnt vmcnt(9)
    v_mfma_f32_16x16x32_bf16 v[144:147], v[132:135], a[4:7], v[144:147]
    buffer_load_dwordx4 v[76:79], v6, s[12:15], s1 offen sc1
    v_mfma_f32_16x16x32_bf16 v[148:151], v[136:139], a[4:7], v[148:151]
    s_and_b32 s4, s52, 1
    s_mul_i32 s4, s4, 20480
    s_mul_i32 s5, s52, 5120
    v_mfma_f32_16x16x32_bf16 v[152:155], v[140:143], a[4:7], v[152:155]
    s_add_u32 s0, s4, s5
    v_add_u32 v8, s0, v1
    v_mfma_f32_16x16x32_bf16 v[156:159], a[204:207], a[4:7], v[156:159]
    buffer_load_dwordx4 v[80:83], v5, s[12:15], s1 offen offset:1024 sc1
    v_mfma_f32_16x16x32_bf16 v[160:163], a[208:211], a[4:7], v[160:163]
    s_waitcnt vmcnt(10)
    v_mfma_f32_16x16x32_bf16 v[164:167], v[132:135], a[8:11], v[164:167]
    s_sub_u32 s4, 20480, s4
    s_add_u32 s0, s4, s5
    v_mfma_f32_16x16x32_bf16 v[168:171], v[136:139], a[8:11], v[168:171]
    v_add_u32 v9, s0, v1
    v_mfma_f32_16x16x32_bf16 v[172:175], v[140:143], a[8:11], v[172:175]
    buffer_load_dwordx4 v[84:87], v6, s[12:15], s1 offen offset:1024 sc1
    v_mfma_f32_16x16x32_bf16 v[176:179], a[204:207], a[8:11], v[176:179]
    v_mfma_f32_16x16x32_bf16 v[180:183], a[208:211], a[8:11], v[180:183]
    s_waitcnt vmcnt(10)
    v_mfma_f32_16x16x32_bf16 v[144:147], a[212:215], a[12:15], v[144:147]
    buffer_load_dwordx4 v[88:91], v5, s[12:15], s1 offen offset:2048 sc1
    v_mfma_f32_16x16x32_bf16 v[148:151], a[216:219], a[12:15], v[148:151]
    v_mfma_f32_16x16x32_bf16 v[152:155], a[220:223], a[12:15], v[152:155]
    v_mfma_f32_16x16x32_bf16 v[156:159], a[224:227], a[12:15], v[156:159]
    buffer_load_dwordx4 v[92:95], v6, s[12:15], s1 offen offset:2048 sc1
    v_mfma_f32_16x16x32_bf16 v[160:163], a[228:231], a[12:15], v[160:163]
    s_waitcnt vmcnt(11)
    v_mfma_f32_16x16x32_bf16 v[164:167], a[212:215], a[16:19], v[164:167]
    v_mfma_f32_16x16x32_bf16 v[168:171], a[216:219], a[16:19], v[168:171]
    v_mfma_f32_16x16x32_bf16 v[172:175], a[220:223], a[16:19], v[172:175]
    v_mfma_f32_16x16x32_bf16 v[176:179], a[224:227], a[16:19], v[176:179]
    buffer_load_dwordx4 v[96:99], v5, s[12:15], s1 offen offset:3072 sc1
    v_mfma_f32_16x16x32_bf16 v[180:183], a[228:231], a[16:19], v[180:183]
    s_waitcnt vmcnt(11)
    v_mfma_f32_16x16x32_bf16 v[144:147], a[232:235], v[56:59], v[144:147]
    v_mfma_f32_16x16x32_bf16 v[148:151], a[236:239], v[56:59], v[148:151]
    v_mfma_f32_16x16x32_bf16 v[152:155], a[56:59], v[56:59], v[152:155]
    buffer_load_dwordx4 v[100:103], v6, s[12:15], s1 offen offset:3072 sc1
    v_mfma_f32_16x16x32_bf16 v[156:159], a[88:91], v[56:59], v[156:159]
    v_mfma_f32_16x16x32_bf16 v[160:163], a[96:99], v[56:59], v[160:163]
    s_waitcnt vmcnt(11)
    v_mfma_f32_16x16x32_bf16 v[164:167], a[232:235], v[60:63], v[164:167]
    buffer_load_dwordx4 v[104:107], v1, s[12:15], s65 offen offset:2048 sc1
    v_mfma_f32_16x16x32_bf16 v[168:171], a[236:239], v[60:63], v[168:171]
    v_mfma_f32_16x16x32_bf16 v[172:175], a[56:59], v[60:63], v[172:175]
    v_mfma_f32_16x16x32_bf16 v[176:179], a[88:91], v[60:63], v[176:179]
    buffer_load_dwordx4 v[16:19], v1, s[12:15], s65 offen offset:3072 sc1
    v_mfma_f32_16x16x32_bf16 v[180:183], a[96:99], v[60:63], v[180:183]
    s_waitcnt vmcnt(12)
    v_mfma_f32_16x16x32_bf16 v[144:147], a[64:67], v[64:67], v[144:147]
    v_mfma_f32_16x16x32_bf16 v[148:151], a[104:107], v[64:67], v[148:151]
    v_mfma_f32_16x16x32_bf16 v[152:155], a[108:111], v[64:67], v[152:155]
    s_add_u32 s65, s65, 4096
    buffer_load_dwordx4 v[20:23], v1, s[12:15], s65 offen sc1
    v_mfma_f32_16x16x32_bf16 v[156:159], a[112:115], v[64:67], v[156:159]
    v_mfma_f32_16x16x32_bf16 v[160:163], a[116:119], v[64:67], v[160:163]
    s_waitcnt vmcnt(12)
    v_mfma_f32_16x16x32_bf16 v[164:167], a[64:67], v[68:71], v[164:167]
    s_add_u32 s1, s1, 4096
    buffer_load_dwordx4 v[24:27], v5, s[12:15], s1 offen sc1
    v_mfma_f32_16x16x32_bf16 v[168:171], a[104:107], v[68:71], v[168:171]
    v_mfma_f32_16x16x32_bf16 v[172:175], a[108:111], v[68:71], v[172:175]
    v_mfma_f32_16x16x32_bf16 v[176:179], a[112:115], v[68:71], v[176:179]
    v_mfma_f32_16x16x32_bf16 v[180:183], a[116:119], v[68:71], v[180:183]
    s_load_dwordx16 s[36:51], s[34:35], s32
    s_waitcnt vmcnt(11)
    v_mfma_f32_16x16x32_bf16 v[144:147], a[72:75], v[72:75], v[144:147]
    buffer_load_dwordx4 v[28:31], v6, s[12:15], s1 offen sc1
    v_mfma_f32_16x16x32_bf16 v[148:151], a[76:79], v[72:75], v[148:151]
    v_mfma_f32_16x16x32_bf16 v[152:155], a[120:123], v[72:75], v[152:155]
    v_mfma_f32_16x16x32_bf16 v[156:159], a[124:127], v[72:75], v[156:159]
    buffer_load_dwordx4 v[32:35], v13, s[12:15], s65 offen offset:1024 sc1
    v_mfma_f32_16x16x32_bf16 v[160:163], a[128:131], v[72:75], v[160:163]
    s_waitcnt vmcnt(12)
    v_mfma_f32_16x16x32_bf16 v[164:167], a[72:75], v[76:79], v[164:167]
    v_mfma_f32_16x16x32_bf16 v[168:171], a[76:79], v[76:79], v[168:171]
    v_mfma_f32_16x16x32_bf16 v[172:175], a[120:123], v[76:79], v[172:175]
    buffer_load_dwordx4 a[136:139], v13, s[12:15], s65 offen offset:2048 sc1
    v_mfma_f32_16x16x32_bf16 v[176:179], a[124:127], v[76:79], v[176:179]
    v_mfma_f32_16x16x32_bf16 v[180:183], a[128:131], v[76:79], v[180:183]
    s_waitcnt vmcnt(12)
    v_mfma_f32_16x16x32_bf16 v[144:147], a[132:135], v[80:83], v[144:147]
    v_mfma_f32_16x16x32_bf16 v[148:151], a[80:83], v[80:83], v[148:151]
    buffer_load_dwordx4 a[140:143], v13, s[12:15], s65 offen offset:3072 sc1
    v_mfma_f32_16x16x32_bf16 v[152:155], a[164:167], v[80:83], v[152:155]
    v_mfma_f32_16x16x32_bf16 v[156:159], a[168:171], v[80:83], v[156:159]
    v_mfma_f32_16x16x32_bf16 v[160:163], a[172:175], v[80:83], v[160:163]
    s_waitcnt vmcnt(12)
    v_mfma_f32_16x16x32_bf16 v[164:167], a[132:135], v[84:87], v[164:167]
    s_add_u32 s65, s65, 4096
    buffer_load_dwordx4 a[144:147], v13, s[12:15], s65 offen sc1
    v_mfma_f32_16x16x32_bf16 v[168:171], a[80:83], v[84:87], v[168:171]
    v_mfma_f32_16x16x32_bf16 v[172:175], a[164:167], v[84:87], v[172:175]
    buffer_load_dwordx4 a[148:151], v13, s[12:15], s65 offen offset:1024 sc1
    v_mfma_f32_16x16x32_bf16 v[176:179], a[168:171], v[84:87], v[176:179]
    v_mfma_f32_16x16x32_bf16 v[180:183], a[172:175], v[84:87], v[180:183]
    s_waitcnt vmcnt(13)
    v_mfma_f32_16x16x32_bf16 v[144:147], v[184:187], v[88:91], v[144:147]
    s_waitcnt lgkmcnt(0)
    s_xor_b64 s[36:37], s[36:37], s[6:7]
    s_xor_b64 s[38:39], s[38:39], s[6:7]
    s_or_b64 s[36:37], s[36:37], s[38:39]
    v_mfma_f32_16x16x32_bf16 v[148:151], v[188:191], v[88:91], v[148:151]
    v_add_u32 v2, s69, v6
    buffer_load_dwordx4 a[152:155], v2, s[12:15], s1 offen offset:1024 sc1
    v_mfma_f32_16x16x32_bf16 v[152:155], v[192:195], v[88:91], v[152:155]
    s_xor_b64 s[40:41], s[40:41], s[6:7]
    s_or_b64 s[36:37], s[36:37], s[40:41]
    v_mfma_f32_16x16x32_bf16 v[156:159], v[196:199], v[88:91], v[156:159]
    s_xor_b64 s[42:43], s[42:43], s[6:7]
    s_or_b64 s[36:37], s[36:37], s[42:43]
    v_mfma_f32_16x16x32_bf16 v[160:163], a[176:179], v[88:91], v[160:163]
    s_waitcnt vmcnt(13)
    v_mfma_f32_16x16x32_bf16 v[164:167], v[184:187], v[92:95], v[164:167]
    s_xor_b64 s[44:45], s[44:45], s[6:7]
    s_or_b64 s[36:37], s[36:37], s[44:45]
    v_mfma_f32_16x16x32_bf16 v[168:171], v[188:191], v[92:95], v[168:171]
    s_xor_b64 s[46:47], s[46:47], s[6:7]
    s_or_b64 s[36:37], s[36:37], s[46:47]
    v_mfma_f32_16x16x32_bf16 v[172:175], v[192:195], v[92:95], v[172:175]
    s_xor_b64 s[48:49], s[48:49], s[6:7]
    s_or_b64 s[36:37], s[36:37], s[48:49]
    v_mfma_f32_16x16x32_bf16 v[176:179], v[196:199], v[92:95], v[176:179]
    s_xor_b64 s[50:51], s[50:51], s[6:7]
    s_or_b64 s[36:37], s[36:37], s[50:51]
    v_mfma_f32_16x16x32_bf16 v[180:183], a[176:179], v[92:95], v[180:183]
    s_waitcnt vmcnt(12)
    v_mfma_f32_16x16x32_bf16 v[144:147], a[180:183], v[96:99], v[144:147]
    s_mov_b32 s3, 0
    s_branch L_first_62
L_retry_61:
    s_waitcnt lgkmcnt(0)
    s_add_u32 s3, s3, 1
    s_cmp_gt_u32 s3, 0x20000
    s_cbranch_scc1 L_done_63
    s_cmp_lt_u32 s3, 32
    s_cbranch_scc0 L_else_64
    s_add_u32 s32, s32, 128
    s_load_dwordx16 s[36:51], s[34:35], s32
    s_branch L_join_65
L_else_64:
    s_load_dwordx16 s[36:51], s[34:35], s32 glc
L_join_65:
    s_waitcnt lgkmcnt(0)
    s_xor_b64 s[36:37], s[36:37], s[6:7]
    s_xor_b64 s[38:39], s[38:39], s[6:7]
    s_or_b64 s[36:37], s[36:37], s[38:39]
    s_xor_b64 s[40:41], s[40:41], s[6:7]
    s_or_b64 s[36:37], s[36:37], s[40:41]
    s_xor_b64 s[42:43], s[42:43], s[6:7]
    s_or_b64 s[36:37], s[36:37], s[42:43]
    s_xor_b64 s[44:45], s[44:45], s[6:7]
    s_or_b64 s[36:37], s[36:37], s[44:45]
    s_xor_b64 s[46:47], s[46:47], s[6:7]
    s_or_b64 s[36:37], s[36:37], s[46:47]
    s_xor_b64 s[48:49], s[48:49], s[6:7]
    s_or_b64 s[36:37], s[36:37], s[48:49]
    s_xor_b64 s[50:51], s[50:51], s[6:7]
    s_or_b64 s[36:37], s[36:37], s[50:51]
L_first_62:
    s_cmp_lg_u64 s[36:37], 0
    s_cbranch_scc1 L_retry_61
L_done_63:
    v_mfma_f32_16x16x32_bf16 v[148:151], a[184:187], v[96:99], v[148:151]
    s_add_u32 s1, s1, 98304
    buffer_load_dwordx4 a[156:159], v5, s[12:15], s1 offen sc1
    v_mfma_f32_16x16x32_bf16 v[152:155], a[188:191], v[96:99], v[152:155]
    buffer_load_dwordx4 a[160:163], v6, s[12:15], s1 offen sc1
    v_mfma_f32_16x16x32_bf16 v[156:159], a[192:195], v[96:99], v[156:159]
    buffer_load_dwordx4 a[0:3], v5, s[12:15], s1 offen offset:1024 sc1
    v_mfma_f32_16x16x32_bf16 v[160:163], a[196:199], v[96:99], v[160:163]
    s_waitcnt vmcnt(14)
    v_mfma_f32_16x16x32_bf16 v[164:167], a[180:183], v[100:103], v[164:167]
    v_mfma_f32_16x16x32_bf16 v[168:171], a[184:187], v[100:103], v[168:171]
    buffer_load_dwordx4 v[240:243], v6, s[12:15], s1 offen offset:1024 sc1
    v_mfma_f32_16x16x32_bf16 v[172:175], a[188:191], v[100:103], v[172:175]
    v_mfma_f32_16x16x32_bf16 v[176:179], a[192:195], v[100:103], v[176:179]
    v_mfma_f32_16x16x32_bf16 v[180:183], a[196:199], v[100:103], v[180:183]
    s_waitcnt vmcnt(11)
    v_mfma_f32_16x16x32_bf16 v[144:147], a[200:203], v[24:27], v[144:147]
    buffer_load_dwordx4 v[244:247], v5, s[12:15], s1 offen offset:2048 sc1
    v_mfma_f32_16x16x32_bf16 v[148:151], a[84:87], v[24:27], v[148:151]
    v_mfma_f32_16x16x32_bf16 v[152:155], v[104:107], v[24:27], v[152:155]
    buffer_load_dwordx4 v[248:251], v6, s[12:15], s1 offen offset:2048 sc1
    v_mfma_f32_16x16x32_bf16 v[156:159], v[16:19], v[24:27], v[156:159]
    v_mfma_f32_16x16x32_bf16 v[160:163], v[20:23], v[24:27], v[160:163]
    s_waitcnt vmcnt(12)
    v_mfma_f32_16x16x32_bf16 v[164:167], a[200:203], v[28:31], v[164:167]
    v_mfma_f32_16x16x32_bf16 v[168:171], a[84:87], v[28:31], v[168:171]
    buffer_load_dwordx4 v[252:255], v5, s[12:15], s1 offen offset:3072 sc1
    v_mfma_f32_16x16x32_bf16 v[172:175], v[104:107], v[28:31], v[172:175]
    v_mfma_f32_16x16x32_bf16 v[176:179], v[16:19], v[28:31], v[176:179]
    v_mfma_f32_16x16x32_bf16 v[180:183], v[20:23], v[28:31], v[180:183]
    buffer_load_dwordx4 a[4:7], v6, s[12:15], s1 offen offset:3072 sc1
    s_add_u32 s1, s1, 4096
    buffer_load_dwordx4 a[8:11], v5, s[12:15], s1 offen sc1
    s_waitcnt vmcnt(9)
    v_mfma_f32_16x16x32_bf16 v[164:167], v[32:35], a[152:155], v[164:167]
    buffer_load_dwordx4 a[12:15], v6, s[12:15], s1 offen sc1
    v_mfma_f32_16x16x32_bf16 v[168:171], a[136:139], a[152:155], v[168:171]
    v_mfma_f32_16x16x32_bf16 v[172:175], a[140:143], a[152:155], v[172:175]
    v_mfma_f32_16x16x32_bf16 v[176:179], a[144:147], a[152:155], v[176:179]
    buffer_load_dwordx4 a[16:19], v5, s[12:15], s1 offen offset:1024 sc1
    v_mfma_f32_16x16x32_bf16 v[180:183], a[148:151], a[152:155], v[180:183]
    s_waitcnt vmcnt(10)
    v_mfma_f32_16x16x32_bf16 v[200:203], a[240:243], a[156:159], 0
    ds_write_b128 v8, v[144:147] offset:0
    v_mfma_f32_16x16x32_bf16 v[204:207], a[20:23], a[156:159], 0
    ds_write_b128 v8, v[148:151] offset:1024
    v_mfma_f32_16x16x32_bf16 v[208:211], a[24:27], a[156:159], 0
    buffer_load_dwordx4 v[56:59], v6, s[12:15], s1 offen offset:1024 sc1
    v_mfma_f32_16x16x32_bf16 v[212:215], a[28:31], a[156:159], 0
    buffer_load_dwordx4 v[60:63], v5, s[12:15], s1 offen offset:2048 sc1
    v_mfma_f32_16x16x32_bf16 v[216:219], a[32:35], a[156:159], 0
    s_waitcnt vmcnt(11)
    v_mfma_f32_16x16x32_bf16 v[220:223], a[240:243], a[160:163], 0
    ds_write_b128 v8, v[152:155] offset:2048
    v_mfma_f32_16x16x32_bf16 v[224:227], a[20:23], a[160:163], 0
    buffer_load_dwordx4 v[64:67], v6, s[12:15], s1 offen offset:2048 sc1
    v_mfma_f32_16x16x32_bf16 v[228:231], a[24:27], a[160:163], 0
    ds_write_b128 v8, v[156:159] offset:3072
    v_mfma_f32_16x16x32_bf16 v[232:235], a[28:31], a[160:163], 0
    ds_write_b128 v8, v[160:163] offset:4096
    v_mfma_f32_16x16x32_bf16 v[236:239], a[32:35], a[160:163], 0
    s_waitcnt vmcnt(11)
    v_mfma_f32_16x16x32_bf16 v[200:203], a[36:39], a[0:3], v[200:203]
    buffer_load_dwordx4 v[68:71], v5, s[12:15], s1 offen offset:3072 sc1
    v_mfma_f32_16x16x32_bf16 v[204:207], a[40:43], a[0:3], v[204:207]
    buffer_load_dwordx4 v[72:75], v6, s[12:15], s1 offen offset:3072 sc1
    v_mfma_f32_16x16x32_bf16 v[208:211], a[44:47], a[0:3], v[208:211]
    ds_write_b128 v9, v[164:167] offset:0
    v_mfma_f32_16x16x32_bf16 v[212:215], a[48:51], a[0:3], v[212:215]
    ds_write_b128 v9, v[168:171] offset:1024
    v_mfma_f32_16x16x32_bf16 v[216:219], a[52:55], a[0:3], v[216:219]
    s_waitcnt vmcnt(12)
    v_mfma_f32_16x16x32_bf16 v[220:223], a[36:39], v[240:243], v[220:223]
    s_add_u32 s1, s1, 4096
    buffer_load_dwordx4 v[76:79], v5, s[12:15], s1 offen sc1
    v_mfma_f32_16x16x32_bf16 v[224:227], a[40:43], v[240:243], v[224:227]
    ds_write_b128 v9, v[172:175] offset:2048
    v_mfma_f32_16x16x32_bf16 v[228:231], a[44:47], v[240:243], v[228:231]
    buffer_load_dwordx4 v[80:83], v6, s[12:15], s1 offen sc1
    v_mfma_f32_16x16x32_bf16 v[232:235], a[48:51], v[240:243], v[232:235]
    ds_write_b128 v9, v[176:179] offset:3072
    v_mfma_f32_16x16x32_bf16 v[236:239], a[52:55], v[240:243], v[236:239]
    s_waitcnt vmcnt(13)
    v_mfma_f32_16x16x32_bf16 v[200:203], a[60:63], v[244:247], v[200:203]
    buffer_load_dwordx4 v[84:87], v5, s[12:15], s1 offen offset:1024 sc1
    v_mfma_f32_16x16x32_bf16 v[204:207], a[92:95], v[244:247], v[204:207]
    ds_write_b128 v9, v[180:183] offset:4096
    v_mfma_f32_16x16x32_bf16 v[208:211], a[100:103], v[244:247], v[208:211]
    buffer_load_dwordx4 v[88:91], v6, s[12:15], s1 offen offset:1024 sc1
    v_mfma_f32_16x16x32_bf16 v[212:215], a[68:71], v[244:247], v[212:215]
    s_and_b32 s4, s53, 1
    s_lshl_b32 s5, s4, 6
    s_add_u32 s5, s5, 153600
    v_mfma_f32_16x16x32_bf16 v[216:219], v[108:111], v[244:247], v[216:219]
    s_waitcnt vmcnt(14)
    v_mfma_f32_16x16x32_bf16 v[220:223], a[60:63], v[248:251], v[220:223]
    buffer_load_dwordx4 v[92:95], v6, s[12:15], s1 offen offset:2048 sc1
    v_mfma_f32_16x16x32_bf16 v[224:227], a[92:95], v[248:251], v[224:227]
    v_lshl_add_u32 v10, v4, 5, s5
    s_xor_b32 s4, s4, 1
    v_mfma_f32_16x16x32_bf16 v[228:231], a[100:103], v[248:251], v[228:231]
    s_lshl_b32 s4, s4, 8
    s_add_u32 s4, s4, 153600
    v_mfma_f32_16x16x32_bf16 v[232:235], a[68:71], v[248:251], v[232:235]
    v_and_b32 v11, 1, v4
    v_lshl_add_u32 v11, v11, 5, s4
    v_mfma_f32_16x16x32_bf16 v[236:239], v[108:111], v[248:251], v[236:239]
    s_waitcnt vmcnt(14)
    v_mfma_f32_16x16x32_bf16 v[200:203], v[112:115], v[252:255], v[200:203]
    buffer_load_dwordx4 v[96:99], v6, s[12:15], s1 offen offset:3072 sc1
    v_mfma_f32_16x16x32_bf16 v[204:207], v[116:119], v[252:255], v[204:207]
    v_lshrrev_b32 v15, 1, v4
    v_lshl_add_u32 v11, v15, 4, v11
    v_mfma_f32_16x16x32_bf16 v[208:211], v[120:123], v[252:255], v[208:211]
    ds_read_b128 v[164:167], v10 offset:960
    ds_read_b128 v[168:171], v10 offset:976
    v_mfma_f32_16x16x32_bf16 v[212:215], v[124:127], v[252:255], v[212:215]
    s_add_u32 s1, s1, 4096
    buffer_load_dwordx4 v[100:103], v6, s[12:15], s1 offen sc1
    v_mfma_f32_16x16x32_bf16 v[216:219], v[128:131], v[252:255], v[216:219]
    s_waitcnt vmcnt(15)
    v_mfma_f32_16x16x32_bf16 v[220:223], v[112:115], a[4:7], v[220:223]
    ds_read_b128 v[172:175], v10 offset:1088
    ds_read_b128 v[176:179], v10 offset:1104
    v_mfma_f32_16x16x32_bf16 v[224:227], v[116:119], a[4:7], v[224:227]
    ds_read_b128 v[180:183], v11 offset:960
    v_accvgpr_read_b32 v37, a244
    v_mfma_f32_16x16x32_bf16 v[228:231], v[120:123], a[4:7], v[228:231]
    v_add_u32 v2, s69, v6
    buffer_load_dwordx4 v[24:27], v2, s[12:15], s1 offen offset:1024 sc1
    v_mfma_f32_16x16x32_bf16 v[232:235], v[124:127], a[4:7], v[232:235]
    v_lshlrev_b32 v36, 16, v37
    v_and_b32 v37, s71, v37
    v_mfma_f32_16x16x32_bf16 v[236:239], v[128:131], a[4:7], v[236:239]
    s_waitcnt vmcnt(15)
    v_mfma_f32_16x16x32_bf16 v[200:203], v[132:135], a[8:11], v[200:203]
    v_accvgpr_read_b32 v39, a245
    v_lshlrev_b32 v38, 16, v39
    v_mfma_f32_16x16x32_bf16 v[204:207], v[136:139], a[8:11], v[204:207]
    s_sub_u32 s1, s1, 4096
    buffer_load_dwordx4 v[28:31], v5, s[12:15], s1 offen offset:2048 sc1
    v_mfma_f32_16x16x32_bf16 v[208:211], v[140:143], a[8:11], v[208:211]
    v_and_b32 v39, s71, v39
    v_accvgpr_read_b32 v41, a246
    v_mfma_f32_16x16x32_bf16 v[212:215], a[204:207], a[8:11], v[212:215]
    v_lshlrev_b32 v40, 16, v41
    v_and_b32 v41, s71, v41
    v_mfma_f32_16x16x32_bf16 v[216:219], a[208:211], a[8:11], v[216:219]
    s_waitcnt vmcnt(15)
    v_mfma_f32_16x16x32_bf16 v[220:223], v[132:135], a[12:15], v[220:223]
    buffer_load_dwordx4 a[152:155], v5, s[12:15], s1 offen offset:3072 sc1
    v_mfma_f32_16x16x32_bf16 v[224:227], v[136:139], a[12:15], v[224:227]
    v_accvgpr_read_b32 v43, a247
    v_lshlrev_b32 v42, 16, v43
    v_mfma_f32_16x16x32_bf16 v[228:231], v[140:143], a[12:15], v[228:231]
    s_add_u32 s1, s1, 4096
    buffer_load_dwordx4 a[156:159], v5, s[12:15], s1 offen sc1
    v_mfma_f32_16x16x32_bf16 v[232:235], a[204:207], a[12:15], v[232:235]
    v_and_b32 v43, s71, v43
    v_accvgpr_read_b32 v45, a248
    v_mfma_f32_16x16x32_bf16 v[236:239], a[208:211], a[12:15], v[236:239]
    s_waitcnt vmcnt(16)
    v_mfma_f32_16x16x32_bf16 v[200:203], a[212:215], a[16:19], v[200:203]
    v_lshlrev_b32 v44, 16, v45
    v_and_b32 v45, s71, v45
    v_mfma_f32_16x16x32_bf16 v[204:207], a[216:219], a[16:19], v[204:207]
    v_accvgpr_read_b32 v47, a249
    v_lshlrev_b32 v46, 16, v47
    v_mfma_f32_16x16x32_bf16 v[208:211], a[220:223], a[16:19], v[208:211]
    v_and_b32 v47, s71, v47
    v_accvgpr_read_b32 v49, a250
    v_mfma_f32_16x16x32_bf16 v[212:215], a[224:227], a[16:19], v[212:215]
    v_lshlrev_b32 v48, 16, v49
    v_and_b32 v49, s71, v49
    v_mfma_f32_16x16x32_bf16 v[216:219], a[228:231], a[16:19], v[216:219]
    s_waitcnt vmcnt(15)
    v_mfma_f32_16x16x32_bf16 v[220:223], a[212:215], v[56:59], v[220:223]
    v_accvgpr_read_b32 v51, a251
    v_lshlrev_b32 v50, 16, v51
    v_mfma_f32_16x16x32_bf16 v[224:227], a[216:219], v[56:59], v[224:227]
    v_and_b32 v51, s71, v51
    v_accvgpr_read_b32 v53, a252
    v_mfma_f32_16x16x32_bf16 v[228:231], a[220:223], v[56:59], v[228:231]
    v_lshlrev_b32 v52, 16, v53
    v_and_b32 v53, s71, v53
    v_mfma_f32_16x16x32_bf16 v[232:235], a[224:227], v[56:59], v[232:235]
    v_accvgpr_read_b32 v55, a253
    v_lshlrev_b32 v54, 16, v55
    v_mfma_f32_16x16x32_bf16 v[236:239], a[228:231], v[56:59], v[236:239]
    s_waitcnt vmcnt(14)
    v_mfma_f32_16x16x32_bf16 v[200:203], a[232:235], v[60:63], v[200:203]
    v_and_b32 v55, s71, v55
    s_add_u32 s4, s52, 1
    v_mfma_f32_16x16x32_bf16 v[204:207], a[236:239], v[60:63], v[204:207]
    s_and_b32 s4, s4, 3
    s_lshl_b32 s5, s52, 2
    s_add_u32 s4, s4, s5
    v_mfma_f32_16x16x32_bf16 v[208:211], a[56:59], v[60:63], v[208:211]
    s_mul_i32 s4, s4, 5120
    v_add_u32 v10, s4, v1
    v_mfma_f32_16x16x32_bf16 v[212:215], a[88:91], v[60:63], v[212:215]
    s_add_u32 s4, s52, 2
    s_and_b32 s4, s4, 3
    s_lshl_b32 s5, s52, 2
    v_mfma_f32_16x16x32_bf16 v[216:219], a[96:99], v[60:63], v[216:219]
    s_waitcnt vmcnt(13)
    v_mfma_f32_16x16x32_bf16 v[220:223], a[232:235], v[64:67], v[220:223]
    s_add_u32 s4, s4, s5
    s_mul_i32 s4, s4, 5120
    v_mfma_f32_16x16x32_bf16 v[224:227], a[236:239], v[64:67], v[224:227]
    v_add_u32 v11, s4, v1
    s_add_u32 s4, s52, 3
    v_mfma_f32_16x16x32_bf16 v[228:231], a[56:59], v[64:67], v[228:231]
    s_and_b32 s4, s4, 3
    s_lshl_b32 s5, s52, 2
    s_add_u32 s4, s4, s5
    v_mfma_f32_16x16x32_bf16 v[232:235], a[88:91], v[64:67], v[232:235]
    s_mul_i32 s4, s4, 5120
    v_add_u32 v12, s4, v1
    v_mfma_f32_16x16x32_bf16 v[236:239], a[96:99], v[64:67], v[236:239]
    s_waitcnt vmcnt(12)
    v_mfma_f32_16x16x32_bf16 v[200:203], a[64:67], v[68:71], v[200:203]
    v_mul_u32_u24 v14, 1280, v3
    v_and_b32 v15, 1, v4
    v_mfma_f32_16x16x32_bf16 v[204:207], a[104:107], v[68:71], v[204:207]
    v_lshl_add_u32 v15, v15, 4, v14
    v_lshrrev_b32 v7, 1, v4
    v_mfma_f32_16x16x32_bf16 v[208:211], a[108:111], v[68:71], v[208:211]
    v_lshl_add_u32 v15, v7, 3, v15
    v_lshl_add_u32 v14, v4, 4, v14
    v_mfma_f32_16x16x32_bf16 v[212:215], a[112:115], v[68:71], v[212:215]
    s_lshl_b32 s4, s54, 2
    s_add_u32 s4, s4, s52
    s_mul_i32 s4, s4, 20480
    v_mfma_f32_16x16x32_bf16 v[216:219], a[116:119], v[68:71], v[216:219]
    s_waitcnt vmcnt(11)
    v_mfma_f32_16x16x32_bf16 v[220:223], a[64:67], v[72:75], v[220:223]
    s_mul_i32 s5, s53, 160
    s_add_u32 s4, s4, s5
    s_and_b32 s6, s53, 1
    v_mfma_f32_16x16x32_bf16 v[224:227], a[104:107], v[72:75], v[224:227]
    s_xor_b32 s5, s6, 1
    s_lshl_b32 s5, s5, 7
    s_add_u32 s5, s5, s4
    v_mfma_f32_16x16x32_bf16 v[228:231], a[108:111], v[72:75], v[228:231]
    s_lshl_b32 s6, s6, 5
    s_add_u32 s4, s4, s6
    v_mfma_f32_16x16x32_bf16 v[232:235], a[112:115], v[72:75], v[232:235]
    v_mfma_f32_16x16x32_bf16 v[236:239], a[116:119], v[72:75], v[236:239]
    s_waitcnt vmcnt(10)
    v_mfma_f32_16x16x32_bf16 v[200:203], a[72:75], v[76:79], v[200:203]
    v_mfma_f32_16x16x32_bf16 v[204:207], a[76:79], v[76:79], v[204:207]
    v_mfma_f32_16x16x32_bf16 v[208:211], a[120:123], v[76:79], v[208:211]
    v_mfma_f32_16x16x32_bf16 v[212:215], a[124:127], v[76:79], v[212:215]
    v_mfma_f32_16x16x32_bf16 v[216:219], a[128:131], v[76:79], v[216:219]
    s_waitcnt vmcnt(9)
    v_mfma_f32_16x16x32_bf16 v[220:223], a[72:75], v[80:83], v[220:223]
    v_mfma_f32_16x16x32_bf16 v[224:227], a[76:79], v[80:83], v[224:227]
    v_mfma_f32_16x16x32_bf16 v[228:231], a[120:123], v[80:83], v[228:231]
    v_mfma_f32_16x16x32_bf16 v[232:235], a[124:127], v[80:83], v[232:235]
    v_mfma_f32_16x16x32_bf16 v[236:239], a[128:131], v[80:83], v[236:239]
    s_waitcnt vmcnt(8)
    v_mfma_f32_16x16x32_bf16 v[200:203], a[132:135], v[84:87], v[200:203]
    v_mfma_f32_16x16x32_bf16 v[204:207], a[80:83], v[84:87], v[204:207]
    v_mfma_f32_16x16x32_bf16 v[208:211], a[164:167], v[84:87], v[208:211]
    v_mfma_f32_16x16x32_bf16 v[212:215], a[168:171], v[84:87], v[212:215]
    v_mfma_f32_16x16x32_bf16 v[216:219], a[172:175], v[84:87], v[216:219]
    s_waitcnt vmcnt(7)
    v_mfma_f32_16x16x32_bf16 v[220:223], a[132:135], v[88:91], v[220:223]
    v_mfma_f32_16x16x32_bf16 v[224:227], a[80:83], v[88:91], v[224:227]
    v_mfma_f32_16x16x32_bf16 v[228:231], a[164:167], v[88:91], v[228:231]
    v_mfma_f32_16x16x32_bf16 v[232:235], a[168:171], v[88:91], v[232:235]
    v_mfma_f32_16x16x32_bf16 v[236:239], a[172:175], v[88:91], v[236:239]
    s_waitcnt vmcnt(6)
    v_mfma_f32_16x16x32_bf16 v[220:223], v[184:187], v[92:95], v[220:223]
    v_mfma_f32_16x16x32_bf16 v[224:227], v[188:191], v[92:95], v[224:227]
    v_mfma_f32_16x16x32_bf16 v[228:231], v[192:195], v[92:95], v[228:231]
    v_mfma_f32_16x16x32_bf16 v[232:235], v[196:199], v[92:95], v[232:235]
    v_mfma_f32_16x16x32_bf16 v[236:239], a[176:179], v[92:95], v[236:239]
    s_waitcnt vmcnt(5)
    v_mfma_f32_16x16x32_bf16 v[220:223], a[180:183], v[96:99], v[220:223]
    v_mfma_f32_16x16x32_bf16 v[224:227], a[184:187], v[96:99], v[224:227]
    v_mfma_f32_16x16x32_bf16 v[228:231], a[188:191], v[96:99], v[228:231]
    v_mfma_f32_16x16x32_bf16 v[232:235], a[192:195], v[96:99], v[232:235]
    v_mfma_f32_16x16x32_bf16 v[236:239], a[196:199], v[96:99], v[236:239]
    s_waitcnt vmcnt(4)
    v_mfma_f32_16x16x32_bf16 v[220:223], a[200:203], v[100:103], v[220:223]
    v_mfma_f32_16x16x32_bf16 v[224:227], a[84:87], v[100:103], v[224:227]
    v_mfma_f32_16x16x32_bf16 v[228:231], v[104:107], v[100:103], v[228:231]
    v_mfma_f32_16x16x32_bf16 v[232:235], v[16:19], v[100:103], v[232:235]
    v_mfma_f32_16x16x32_bf16 v[236:239], v[20:23], v[100:103], v[236:239]
    s_waitcnt vmcnt(3)
    v_mfma_f32_16x16x32_bf16 v[220:223], v[32:35], v[24:27], v[220:223]
    v_mfma_f32_16x16x32_bf16 v[224:227], a[136:139], v[24:27], v[224:227]
    v_mfma_f32_16x16x32_bf16 v[228:231], a[140:143], v[24:27], v[228:231]
    v_mfma_f32_16x16x32_bf16 v[232:235], a[144:147], v[24:27], v[232:235]
    v_mfma_f32_16x16x32_bf16 v[236:239], a[148:151], v[24:27], v[236:239]
    s_waitcnt vmcnt(2)
    v_mfma_f32_16x16x32_bf16 v[200:203], v[184:187], v[28:31], v[200:203]
    v_mfma_f32_16x16x32_bf16 v[204:207], v[188:191], v[28:31], v[204:207]
    v_mfma_f32_16x16x32_bf16 v[208:211], v[192:195], v[28:31], v[208:211]
    ds_write_b128 v9, v[220:223] offset:40960
    v_mfma_f32_16x16x32_bf16 v[212:215], v[196:199], v[28:31], v[212:215]
    v_mfma_f32_16x16x32_bf16 v[216:219], a[176:179], v[28:31], v[216:219]
    s_waitcnt vmcnt(1)
    v_mfma_f32_16x16x32_bf16 v[200:203], a[180:183], a[152:155], v[200:203]
    ds_write_b128 v9, v[224:227] offset:41984
    v_mfma_f32_16x16x32_bf16 v[204:207], a[184:187], a[152:155], v[204:207]
    v_mfma_f32_16x16x32_bf16 v[208:211], a[188:191], a[152:155], v[208:211]
    ds_write_b128 v9, v[228:231] offset:43008
    v_mfma_f32_16x16x32_bf16 v[212:215], a[192:195], a[152:155], v[212:215]
    v_mfma_f32_16x16x32_bf16 v[216:219], a[196:199], a[152:155], v[216:219]
    s_waitcnt vmcnt(0)
    v_mfma_f32_16x16x32_bf16 v[200:203], a[200:203], a[156:159], v[200:203]
    ds_write_b128 v9, v[232:235] offset:44032
    v_mfma_f32_16x16x32_bf16 v[204:207], a[84:87], a[156:159], v[204:207]
    v_mfma_f32_16x16x32_bf16 v[208:211], v[104:107], a[156:159], v[208:211]
    ds_write_b128 v9, v[236:239] offset:45056
    v_mfma_f32_16x16x32_bf16 v[212:215], v[16:19], a[156:159], v[212:215]
    v_mfma_f32_16x16x32_bf16 v[216:219], v[20:23], a[156:159], v[216:219]
    s_cmp_ge_u32 s52, 2
    s_cbranch_scc0 L_else_66
    v_mov_b64 v[144:145], v[200:201]
    v_mov_b64 v[146:147], v[202:203]
    v_mov_b64 v[148:149], v[204:205]
    v_mov_b64 v[150:151], v[206:207]
    v_mov_b64 v[152:153], v[208:209]
    v_mov_b64 v[154:155], v[210:211]
    v_mov_b64 v[156:157], v[212:213]
    v_mov_b64 v[158:159], v[214:215]
    v_mov_b64 v[160:161], v[216:217]
    v_mov_b64 v[162:163], v[218:219]
    s_branch L_join_67
L_else_66:
    ds_write_b128 v8, v[200:203] offset:40960
    s_nop 0
    ds_write_b128 v8, v[204:207] offset:41984
    ds_write_b128 v8, v[208:211] offset:43008
    s_nop 0
    ds_write_b128 v8, v[212:215] offset:44032
    ds_write_b128 v8, v[216:219] offset:45056
L_join_67:
    s_waitcnt lgkmcnt(0)
    s_barrier
    ds_read_b128 v[56:59], v10 offset:0
    ds_read_b128 v[60:63], v11 offset:0
    ds_read_b128 v[64:67], v12 offset:0
    ds_read_b128 v[68:71], v10 offset:1024
    ds_read_b128 v[72:75], v11 offset:1024
    ds_read_b128 v[76:79], v12 offset:1024
    ds_read_b128 v[80:83], v10 offset:2048
    ds_read_b128 v[84:87], v11 offset:2048
    ds_read_b128 v[88:91], v12 offset:2048
    ds_read_b128 v[92:95], v10 offset:3072
    ds_read_b128 v[96:99], v11 offset:3072
    ds_read_b128 v[100:103], v12 offset:3072
    ds_read_b128 v[104:107], v10 offset:4096
    ds_read_b128 v[108:111], v11 offset:4096
    ds_read_b128 v[112:115], v12 offset:4096
    s_waitcnt lgkmcnt(14)
    v_pk_add_f32 v[144:145], v[144:145], v[56:57]
    v_pk_add_f32 v[146:147], v[146:147], v[58:59]
    s_waitcnt lgkmcnt(12)
    v_pk_add_f32 v[60:61], v[60:61], v[64:65]
    v_pk_add_f32 v[62:63], v[62:63], v[66:67]
    v_pk_add_f32 v[144:145], v[144:145], v[60:61]
    v_pk_add_f32 v[146:147], v[146:147], v[62:63]
    v_pk_fma_f32 v[144:145], v[144:145], v[164:165], v[36:37]
    v_pk_fma_f32 v[146:147], v[146:147], v[166:167], v[38:39]
    v_cvt_pk_bf16_f32 v16, v144, v145
    v_cvt_pk_bf16_f32 v17, v146, v147
    s_waitcnt lgkmcnt(11)
    v_pk_add_f32 v[148:149], v[148:149], v[68:69]
    v_pk_add_f32 v[150:151], v[150:151], v[70:71]
    s_waitcnt lgkmcnt(9)
    v_pk_add_f32 v[72:73], v[72:73], v[76:77]
    v_pk_add_f32 v[74:75], v[74:75], v[78:79]
    v_pk_add_f32 v[148:149], v[148:149], v[72:73]
    v_pk_add_f32 v[150:151], v[150:151], v[74:75]
    v_pk_fma_f32 v[148:149], v[148:149], v[168:169], v[40:41]
    v_pk_fma_f32 v[150:151], v[150:151], v[170:171], v[42:43]
    v_cvt_pk_bf16_f32 v18, v148, v149
    v_cvt_pk_bf16_f32 v19, v150, v151
    buffer_store_dwordx4 v[16:19], v14, s[24:27], s4 offen
    s_waitcnt lgkmcnt(8)
    v_pk_add_f32 v[152:153], v[152:153], v[80:81]
    v_pk_add_f32 v[154:155], v[154:155], v[82:83]
    s_waitcnt lgkmcnt(6)
    v_pk_add_f32 v[84:85], v[84:85], v[88:89]
    v_pk_add_f32 v[86:87], v[86:87], v[90:91]
    v_pk_add_f32 v[152:153], v[152:153], v[84:85]
    v_pk_add_f32 v[154:155], v[154:155], v[86:87]
    v_pk_fma_f32 v[152:153], v[152:153], v[172:173], v[44:45]
    v_pk_fma_f32 v[154:155], v[154:155], v[174:175], v[46:47]
    v_cvt_pk_bf16_f32 v20, v152, v153
    v_cvt_pk_bf16_f32 v21, v154, v155
    s_waitcnt lgkmcnt(5)
    v_pk_add_f32 v[156:157], v[156:157], v[92:93]
    v_pk_add_f32 v[158:159], v[158:159], v[94:95]
    s_waitcnt lgkmcnt(3)
    v_pk_add_f32 v[96:97], v[96:97], v[100:101]
    v_pk_add_f32 v[98:99], v[98:99], v[102:103]
    v_pk_add_f32 v[156:157], v[156:157], v[96:97]
    v_pk_add_f32 v[158:159], v[158:159], v[98:99]
    v_pk_fma_f32 v[156:157], v[156:157], v[176:177], v[48:49]
    v_pk_fma_f32 v[158:159], v[158:159], v[178:179], v[50:51]
    v_cvt_pk_bf16_f32 v22, v156, v157
    v_cvt_pk_bf16_f32 v23, v158, v159
    buffer_store_dwordx4 v[20:23], v14, s[24:27], s4 offen offset:64
    s_waitcnt lgkmcnt(2)
    v_pk_add_f32 v[160:161], v[160:161], v[104:105]
    v_pk_add_f32 v[162:163], v[162:163], v[106:107]
    s_waitcnt lgkmcnt(0)
    v_pk_add_f32 v[108:109], v[108:109], v[112:113]
    v_pk_add_f32 v[110:111], v[110:111], v[114:115]
    v_pk_add_f32 v[160:161], v[160:161], v[108:109]
    v_pk_add_f32 v[162:163], v[162:163], v[110:111]
    v_pk_fma_f32 v[160:161], v[160:161], v[180:181], v[52:53]
    v_pk_fma_f32 v[162:163], v[162:163], v[182:183], v[54:55]
    v_cvt_pk_bf16_f32 v24, v160, v161
    v_cvt_pk_bf16_f32 v25, v162, v163
    buffer_store_dwordx2 v[24:25], v15, s[24:27], s5 offen
    s_lshl_b32 s4, s2, 2
    s_add_u32 s4, s4, s52
    s_cmp_eq_u32 s4, 0
    s_cbranch_scc0 L_else_68
    s_atomic_swap s58, s[34:35], 0
L_else_68:
L_end:
    s_endpgm
L_retry_9:
    s_waitcnt lgkmcnt(0)
    s_mov_b32 s3, 0
L_poll_11:
    s_add_u32 s3, s3, 1
    s_cmp_gt_u32 s3, 0x20000
    s_cbranch_scc1 L_pdone_12
    s_mul_i32 s46, s52, 640
    s_add_u32 s46, s46, 22609920
    buffer_load_dwordx4 v[16:19], v74, s[12:15], s46 offen sc1
    buffer_load_dword v32, v74, s[12:15], s46 offen offset:16 sc1
    s_mul_i32 s46, s52, 640
    s_add_u32 s46, s46, 22625280
    buffer_load_dwordx4 v[20:23], v74, s[12:15], s46 offen sc1
    buffer_load_dword v33, v74, s[12:15], s46 offen offset:16 sc1
    s_mul_i32 s46, s52, 640
    s_add_u32 s46, s46, 22640640
    buffer_load_dwordx4 v[24:27], v74, s[12:15], s46 offen sc1
    buffer_load_dword v34, v74, s[12:15], s46 offen offset:16 sc1
    s_mul_i32 s46, s52, 640
    s_add_u32 s46, s46, 22656000
    buffer_load_dwordx4 v[28:31], v74, s[12:15], s46 offen sc1
    buffer_load_dword v35, v74, s[12:15], s46 offen offset:16 sc1
    s_and_b32 s47, s58, 0xff
    s_waitcnt vmcnt(7)
    v_xor_b32 v16, s47, v16
    v_xor_b32 v17, s47, v17
    v_xor_b32 v18, s47, v18
    v_xor_b32 v19, s47, v19
    s_waitcnt vmcnt(5)
    v_xor_b32 v20, s47, v20
    v_xor_b32 v21, s47, v21
    v_xor_b32 v22, s47, v22
    v_xor_b32 v23, s47, v23
    s_waitcnt vmcnt(3)
    v_xor_b32 v24, s47, v24
    v_xor_b32 v25, s47, v25
    v_xor_b32 v26, s47, v26
    v_xor_b32 v27, s47, v27
    s_waitcnt vmcnt(1)
    v_xor_b32 v28, s47, v28
    v_xor_b32 v29, s47, v29
    v_xor_b32 v30, s47, v30
    v_xor_b32 v31, s47, v31
    v_xor_b32 v32, s47, v32
    v_xor_b32 v33, s47, v33
    v_xor_b32 v34, s47, v34
    s_waitcnt vmcnt(0)
    v_xor_b32 v35, s47, v35
    v_or_b32 v91, v16, v17
    v_or3_b32 v91, v91, v18, v19
    v_or3_b32 v91, v91, v20, v21
    v_or3_b32 v91, v91, v22, v23
    v_or3_b32 v91, v91, v24, v25
    v_or3_b32 v91, v91, v26, v27
    v_or3_b32 v91, v91, v28, v29
    v_or3_b32 v91, v91, v30, v31
    v_or3_b32 v91, v91, v32, v33
    v_or3_b32 v91, v91, v34, v35
    v_and_b32 v91, 0xff, v91
    v_cmp_ne_u32 vcc, 0, v91
    s_cbranch_vccnz L_poll_11
L_pdone_12:
    s_branch L_back_10
L_retry_13:
    s_waitcnt lgkmcnt(0)
    s_mov_b32 s3, 0
L_poll_15:
    s_add_u32 s3, s3, 1
    s_cmp_gt_u32 s3, 0x20000
    s_cbranch_scc1 L_pdone_16
    buffer_load_dwordx2 v[96:97], v92, s[12:15], s61 offen offset:0 sc1
    buffer_load_dwordx2 v[104:105], v92, s[12:15], s61 offen offset:256 sc1
    buffer_load_dwordx2 v[112:113], v92, s[12:15], s61 offen offset:512 sc1
    buffer_load_dwordx2 v[120:121], v92, s[12:15], s61 offen offset:768 sc1
    buffer_load_dwordx2 v[128:129], v92, s[12:15], s61 offen offset:1024 sc1
    s_waitcnt vmcnt(4)
    v_xor_b32 v97, v90, v97
    s_waitcnt vmcnt(3)
    v_xor_b32 v105, v90, v105
    s_waitcnt vmcnt(2)
    v_xor_b32 v113, v90, v113
    s_waitcnt vmcnt(1)
    v_xor_b32 v121, v90, v121
    s_waitcnt vmcnt(0)
    v_xor_b32 v129, v90, v129
    v_or3_b32 v91, v97, v105, v113
    v_or3_b32 v91, v91, v121, v129
    v_cmp_lt_u32 vcc, 0xffff, v91
    s_cbranch_vccnz L_poll_15
L_pdone_16:
    s_branch L_back_14
L_retry_17:
    s_mov_b32 s3, 0
L_poll_19:
    s_add_u32 s3, s3, 1
    s_cmp_gt_u32 s3, 0x20000
    s_cbranch_scc1 L_pdone_20
    s_load_dwordx8 s[72:79], s[34:35], s62 glc
    s_waitcnt lgkmcnt(0)
    s_cmp_lg_u32 s72, s58
    s_cbranch_scc1 L_poll_19
    s_cmp_lg_u32 s73, s58
    s_cbranch_scc1 L_poll_19
    s_cmp_lg_u32 s74, s58
    s_cbranch_scc1 L_poll_19
    s_cmp_lg_u32 s75, s58
    s_cbranch_scc1 L_poll_19
    s_cmp_lg_u32 s76, s58
    s_cbranch_scc1 L_poll_19
L_pdone_20:
    s_branch L_back_18
L_retry_23:
    s_waitcnt lgkmcnt(0)
    s_mov_b32 s3, 0
L_poll_25:
    s_add_u32 s3, s3, 1
    s_cmp_gt_u32 s3, 0x20000
    s_cbranch_scc1 L_pdone_26
    s_sleep 8
    buffer_load_dwordx4 v[40:43], v44, s[12:15], 0 offen sc1
    s_waitcnt vmcnt(0)
    v_xor_b32 v40, s63, v40
    v_xor_b32 v41, s63, v41
    v_xor_b32 v42, s63, v42
    v_xor_b32 v43, s63, v43
    v_or_b32 v40, v40, v41
    v_or3_b32 v40, v40, v42, v43
    v_cmp_ne_u32 s[72:73], 0, v40
    v_cmp_lt_u32 s[74:75], 7, v40
    s_cmp_lg_u64 s[74:75], 0
    s_cbranch_scc1 L_poll_25
L_pdone_26:
    s_branch L_back_24
L_slow_27:
    buffer_store_dword v15, v14, s[12:15], s5 offen sc1
    s_branch L_back_28
L_retry_29:
    s_mov_b32 s3, 0
L_poll_31:
    s_add_u32 s3, s3, 1
    s_cmp_gt_u32 s3, 0x20000
    s_cbranch_scc1 L_pdone_32
    v_and_b32 v45, 31, v0
    v_min_u32 v45, 19, v45
    v_lshrrev_b32 v46, 5, v0
    v_mul_u32_u24 v46, 15360, v46
    v_lshl_add_u32 v45, v45, 4, v46
    s_mul_i32 s46, s52, 2560
    s_mul_i32 s47, s53, 320
    s_add_u32 s46, s46, s47
    s_add_u32 s46, s46, 22615040
    buffer_load_dwordx4 v[48:51], v45, s[12:15], s46 offen sc1
    s_add_u32 s46, s46, 30720
    buffer_load_dwordx4 v[52:55], v45, s[12:15], s46 offen sc1
    s_and_b32 s47, s58, 0xff
    s_waitcnt vmcnt(1)
    v_xor_b32 v48, s47, v48
    v_xor_b32 v49, s47, v49
    v_xor_b32 v50, s47, v50
    v_xor_b32 v51, s47, v51
    s_waitcnt vmcnt(0)
    v_xor_b32 v52, s47, v52
    v_xor_b32 v53, s47, v53
    v_xor_b32 v54, s47, v54
    v_xor_b32 v55, s47, v55
    v_or_b32 v47, v48, v49
    v_or3_b32 v47, v47, v50, v51
    v_or3_b32 v47, v47, v52, v53
    v_or3_b32 v47, v47, v54, v55
    v_and_b32 v47, 0xff, v47
    v_cmp_ne_u32 vcc, 0, v47
    s_cbranch_vccnz L_poll_31
L_pdone_32:
    s_branch L_back_30
L_coherent_36:
    s_load_dwordx8 s[36:43], s[34:35], s4 glc
    s_branch L_back_37
L_slow_38:
    buffer_store_dwordx2 v[16:17], v30, s[12:15], s31 offen sc1
    s_branch L_back_39
L_slow_43:
    buffer_store_dwordx4 v[16:19], v1, s[12:15], s72 offen sc1
    buffer_store_dwordx4 v[20:23], v1, s[12:15], s72 offen offset:1024 sc1
    buffer_store_dwordx4 v[24:27], v32, s[12:15], s73 offen offset:2048 sc1
    s_branch L_back_44
L_slow_45:
    buffer_store_dword v15, v14, s[12:15], s33 offen sc1
    s_branch L_back_46
L_coherent_50:
    s_load_dwordx16 s[36:51], s[34:35], s32 glc
    s_branch L_back_51
L_slow_52:
    buffer_store_dword v15, v14, s[12:15], s33 offen sc1
    s_branch L_back_53
L_slow_59:
    buffer_store_dword v15, v14, s[12:15], s33 offen offset:64 sc1
    s_branch L_back_60
L_last:
.section .rodata,"a"
.p2align 6
.amdhsa_kernel adaLN_cond__sliding_local_dilated__glu_gated_bilinear__prompt_kernel
  .amdhsa_next_free_vgpr 512
  .amdhsa_next_free_sgpr 102
  .amdhsa_accum_offset 256
  .amdhsa_group_segment_fixed_size 0
  .amdhsa_kernarg_size 96
  .amdhsa_user_sgpr_count 2
  .amdhsa_user_sgpr_kernarg_segment_ptr 1
  .amdhsa_system_sgpr_workgroup_id_x 1
.end_amdhsa_kernel
```
